```python
import torch

def _softmax(x, axis=-1):
    return torch.softmax(x, dim=axis)
def _gelu(x):
    return torch.nn.functional.gelu(x, approximate="tanh")
def _silu(x):
    return torch.nn.functional.silu(x)
def _sigmoid(x):
    return torch.sigmoid(x)
def _layernorm(x, axis=-1, eps=1e-5):
    m = x.mean(dim=axis, keepdim=True)
    v = x.var(dim=axis, keepdim=True, unbiased=False)
    return (x - m) / torch.sqrt(v + eps)
def _scatter_add(tgt, idx, src, axis=0):
    return tgt.clone().index_add_(axis, idx, src)
def _segment_sum(src, seg, n):
    out = torch.zeros((n,) + src.shape[1:], dtype=src.dtype)
    return out.index_add_(0, seg, src)
def _pad(x, pw):
    flat = tuple(v for pair in reversed(pw) for v in pair)
    return torch.nn.functional.pad(x, flat)

kernel_name = 'gated_mix__sliding_block_cached__glu_gated_reglu__decode'

def setup_inputs():

    _w = (lambda a: (lambda t: t.to(torch.bfloat16) if t.is_floating_point() else t)(torch.as_tensor(a)))
    def _A_setup():
        B, Sq, D = 1, 1, 576
        Hq, Hkv, Sk, Dh = 32, 16, 65536, 128
        assert Hq % Hkv == 0, (Hq, Hkv)
        return {
            "x": _w((lambda *s: torch.randn(*s, dtype=torch.bfloat16) * 0.05)(B, Sq, D)),
            "k_cache": _w((lambda *s: torch.randn(*s, dtype=torch.bfloat16) * 3.2)(B, Hkv, Sk, Dh)),
            "v_cache": _w((lambda *s: torch.randn(*s, dtype=torch.bfloat16) * 0.05)(B, Hkv, Sk, Dh)),
            "wq": _w((lambda *s: torch.randn(*s, dtype=torch.bfloat16) * 3.2)(D, Hq * Dh) * (D ** -0.5)),
            "wo": _w((lambda *s: torch.randn(*s, dtype=torch.bfloat16) * 0.05)(Hq * Dh, D) * ((Hq * Dh) ** -0.5)),
        }
    _A_in = _A_setup()

    def _B_setup():
        B, S, D, F = 1, 1, 576, 4608
        return {
            "x": _w((lambda *s: torch.randn(*s, dtype=torch.bfloat16) * 0.05)(B, S, D)),
            "W_gate": _w((lambda *s: torch.randn(*s, dtype=torch.bfloat16) * 0.2)(D, F) * (2.0 / D) ** 0.5),
            "W_up": _w((lambda *s: torch.randn(*s, dtype=torch.bfloat16) * 0.2)(D, F) * (2.0 / D) ** 0.5),
            "W_down": _w((lambda *s: torch.randn(*s, dtype=torch.bfloat16) * 0.2)(F, D) * (1.0 / F) ** 0.5),
        }
    _B_in = _B_setup()

    return {
        "A_x": _A_in["x"],
        "A_k_cache": _A_in["k_cache"],
        "A_v_cache": _A_in["v_cache"],
        "A_wq": _A_in["wq"],
        "A_wo": _A_in["wo"],
        "B_x": _B_in["x"],
        "B_W_gate": _B_in["W_gate"],
        "B_W_up": _B_in["W_up"],
        "B_W_down": _B_in["W_down"],
        "gate_w": _w((lambda *s: torch.randn(*s, dtype=torch.bfloat16) * 0.05)(576) * 16.0),
    }

def reference(A_x, A_k_cache, A_v_cache, A_wq, A_wo, B_x, B_W_gate, B_W_up, B_W_down, gate_w):
    def _A_ref(x, k_cache, v_cache, wq, wo):
        B, Sq, D = x.shape
        Hq, Dh = 32, 128
        Hkv, Sk = k_cache.shape[1], k_cache.shape[2]
        W = min(4096, max(256, Sk // 4))
        rep = Hq // Hkv
        q = (lambda x, *d: x.permute(*d))((x @ wq).reshape(B, Sq, Hq, Dh), 0, 2, 1, 3)
        k = (lambda x, n, axis: torch.repeat_interleave(x, n, dim=axis))(k_cache[:, :, Sk - W:, :], rep, axis=1)
        v = (lambda x, n, axis: torch.repeat_interleave(x, n, dim=axis))(v_cache[:, :, Sk - W:, :], rep, axis=1)
        scores = torch.einsum("bhqd,bhkd->bhqk", q, k) * (Dh ** -0.5)
        p = _softmax(scores, axis=-1)
        o = torch.einsum("bhqk,bhkd->bhqd", p, v)
        return (lambda x, *d: x.permute(*d))(o, 0, 2, 1, 3).reshape(B, Sq, Hq * Dh) @ wo

    def _B_ref(x, W_gate, W_up, W_down):
        gate = torch.einsum("bsd,df->bsf", x, W_gate)
        up = torch.einsum("bsd,df->bsf", x, W_up)
        gate = gate * (lambda x, dt: x.to(dt))(gate > 0, gate.dtype)
        h = gate * up
        return torch.einsum("bsf,fd->bsd", h, W_down)

    x = A_x
    g = _sigmoid((x * gate_w).sum(-1, keepdims=True))
    a = _A_ref(x, A_k_cache, A_v_cache, A_wq, A_wo)
    b = _B_ref(x, B_W_gate, B_W_up, B_W_down)
    return g * a + (1 - g) * b
```

```asm
; @launch grid=(256,1,1) block=(256,1,1) lds=90112
.amdgcn_target "amdgcn-amd-amdhsa--gfx950"
.text
.globl gated_mix__sliding_block_cached__glu_gated_reglu__decode_kernel
.p2align 8
.type gated_mix__sliding_block_cached__glu_gated_reglu__decode_kernel,@function
gated_mix__sliding_block_cached__glu_gated_reglu__decode_kernel:
    s_load_dwordx16 s[36:51], s[0:1], 0
    s_cmpk_ge_u32 s2, 0x100
    s_cbranch_scc1 L_end
    s_mov_b32 s101, s2
    s_lshr_b32 s8, s2, 6
    s_mul_i32 s4, s8, 1179648
    s_and_b32 s5, s2, 7
    s_bfe_u32 s6, s2, 0x30003
    s_lshl3_add_u32 s11, s5, s6
    s_lshl_b32 s5, s11, 7
    s_add_u32 s4, s4, s5
    v_lshrrev_b32 v72, 3, v0
    v_and_b32 v73, 7, v0
    v_lshlrev_b32 v73, 4, v73
    v_lshl_add_u32 v10, v72, 15, v73
    s_mov_b32 s66, 1171584
    s_mov_b32 s67, 0x20000
    s_movk_i32 s33, 0x2000
    s_movk_i32 s34, 0x4000
    s_movk_i32 s35, 0x6000
    s_waitcnt lgkmcnt(0)
    s_add_u32 s64, s42, s4
    s_addc_u32 s65, s43, 0
    buffer_load_dwordx4 v[100:103], v10, s[64:67], 0 offen nt
    buffer_load_dwordx4 v[104:107], v10, s[64:67], s33 offen nt
    buffer_load_dwordx4 v[108:111], v10, s[64:67], s34 offen nt
    buffer_load_dwordx4 v[112:115], v10, s[64:67], s35 offen nt
    s_load_dwordx8 s[52:59], s[0:1], 64
    s_load_dwordx2 s[60:61], s[0:1], 96
    s_lshl_b32 s2, s8, 6
    s_add_u32 s2, s2, s11
    v_lshl_add_u32 v11, v72, 13, v73
    v_add_u32 v11, 1048576, v11
    v_lshrrev_b32 v99, 6, v0
    v_lshlrev_b32 v14, 4, v0
    v_readfirstlane_b32 s3, v99
    buffer_load_dwordx4 v[116:119], v11, s[64:67], 0 offen nt
    s_mov_b32 s88, s36
    s_mov_b32 s89, s37
    s_movk_i32 s90, 1152
    s_mov_b32 s91, 0x20000
    buffer_load_dwordx4 v[24:27], v14, s[88:91], 0 offen
    s_bitcmp1_b32 s3, 0
    s_cselect_b32 s68, s50, s48
    s_cselect_b32 s69, s51, s49
    s_cselect_b32 s7, 2, 1
    s_lshr_b32 s6, s3, 1
    s_lshl1_add_u32 s6, s8, s6
    s_mul_i32 s4, s6, 663552
    s_xor_b32 s5, s11, s7
    s_lshl_b32 s5, s5, 7
    s_add_u32 s4, s4, s5
    s_add_u32 s68, s68, s4
    s_addc_u32 s69, s69, 0
    s_mov_b32 s70, 654464
    s_mov_b32 s71, 0x20000
    v_and_b32 v74, 7, v72
    v_mul_u32_u24 v12, 73728, v74
    v_add_u32 v12, v12, v73
    s_mov_b32 s14, 0
    buffer_load_dwordx4 v[120:123], v12, s[68:71], s14 offen nt
    s_addk_i32 s14, 9216
    buffer_load_dwordx4 v[124:127], v12, s[68:71], s14 offen nt
    v_mul_u32_u24 v15, 9216, v74
    v_add_u32 v15, v15, v73
    v_add_u32 v15, 589824, v15
    s_waitcnt lgkmcnt(0)
    s_mov_b32 s76, s54
    s_mov_b32 s77, s55
    s_movk_i32 s78, 1152
    s_mov_b32 s79, 0x20000
    buffer_load_dwordx4 v[28:31], v14, s[76:79], 0 offen
    s_addk_i32 s14, 9216
    buffer_load_dwordx4 v[128:131], v12, s[68:71], s14 offen nt
    s_addk_i32 s14, 9216
    buffer_load_dwordx4 v[132:135], v12, s[68:71], s14 offen nt
    s_addk_i32 s14, 9216
    buffer_load_dwordx4 v[136:139], v12, s[68:71], s14 offen nt
    s_add_u32 s60, s60, 0x0
    s_addc_u32 s61, s61, 0
    s_load_dword s62, s[60:61], 0
    s_bitcmp1_b32 s2, 0
    s_cselect_b32 s76, s50, s48
    s_cselect_b32 s77, s51, s49
    s_bfe_u32 s7, s2, 0x20001
    s_lshl2_add_u32 s7, s8, s7
    s_mul_i32 s4, s7, 331776
    s_lshr_b32 s5, s11, 3
    s_lshl_b32 s5, s5, 7
    s_add_u32 s4, s4, s5
    s_add_u32 s4, s4, 8192
    s_add_u32 s76, s76, s4
    s_addc_u32 s77, s77, 0
    s_mov_b32 s78, 322688
    v_mul_u32_u24 v16, 9216, v72
    v_add_u32 v16, v16, v73
    v_add_u32 v18, 294912, v16
    s_lshr_b32 s9, s11, 2
    s_and_b32 s10, s2, 3
    s_lshl2_add_u32 s10, s8, s10
    s_lshl_b32 s4, s9, 24
    s_lshl_b32 s5, s10, 16
    s_add_u32 s4, s4, s5
    s_add_u32 s4, s4, 15728640
    s_add_u32 s72, s38, s4
    s_addc_u32 s73, s39, 0
    s_mov_b32 s74, 0x10000
    s_mov_b32 s75, 0x20000
    s_add_u32 s92, s40, s4
    s_addc_u32 s93, s41, 0
    s_mov_b32 s94, 0x10000
    s_mov_b32 s95, 0x20000
    s_lshr_b32 s4, s2, 7
    s_mul_i32 s4, s4, 640
    s_add_u32 s80, s52, s4
    s_addc_u32 s81, s53, 0
    s_sub_u32 s82, 5308416, s4
    s_mov_b32 s83, 0x20000
    s_and_b32 s5, s10, 7
    s_lshl3_add_u32 s5, s9, s5
    s_mul_i32 s5, s5, 36864
    s_add_u32 s4, s4, s5
    s_add_u32 s84, s44, s4
    s_addc_u32 s85, s45, 0
    s_mov_b32 s86, 36352
    s_mov_b32 s87, 0x20000
    s_mov_b32 s96, s60
    s_mov_b32 s97, s61
    s_mov_b32 s98, 0x100000
    s_mov_b32 s99, 0x20000
    s_movk_i32 s12, 4608
    v_and_b32 v1, 63, v0
    v_and_b32 v228, 3, v0
    v_lshlrev_b32 v228, 4, v228
    v_bfe_u32 v229, v0, 2, 2
    v_lshl_add_u32 v228, v229, 8, v228
    v_bfe_u32 v229, v0, 4, 2
    v_lshl_add_u32 v228, v229, 6, v228
    v_lshl_add_u32 v13, v99, 10, v228
    v_mov_b32 v17, 0xffffff00
    v_and_b32 v228, 1, v0
    v_lshlrev_b32 v228, 4, v228
    v_mov_b32 v229, 0xffff
    v_lshlrev_b32 v228, v228, v229
    v_bfe_u32 v229, v0, 1, 2
    v_cmp_eq_u32 s[4:5], 0, v229
    v_cmp_eq_u32 s[36:37], 1, v229
    v_cmp_eq_u32 vcc, 2, v229
    v_cndmask_b32 v2, 0, v228, s[4:5]
    v_cndmask_b32 v3, 0, v228, s[36:37]
    v_cmp_eq_u32 s[36:37], 3, v229
    v_cndmask_b32 v4, 0, v228, vcc
    v_or_b32 v231, v2, v4
    v_cndmask_b32 v5, 0, v228, s[36:37]
    v_or_b32 v229, v3, v5
    v_mov_b32 v230, 0x0c0c0c0c
    s_mov_b32 s32, 0x01000100
    s_mov_b32 s63, 0x03020302
    v_bfi_b32 v6, v231, s32, v230
    v_bfi_b32 v7, v229, s32, v230
    v_bfi_b32 v8, v231, s63, v230
    v_bfi_b32 v9, v229, s63, v230
    v_lshlrev_b32 v228, 2, v1
    v_mov_b32 v232, 0
    v_mov_b32 v233, 0
    v_mov_b32 v234, 0
    v_mov_b32 v235, 0
    ds_write_b32 v228, v232 offset:15616
    ds_write_b32 v228, v232 offset:2304
    v_lshlrev_b32 v229, 3, v1
    ds_write_b64 v229, v[232:233] offset:31232
    v_and_b32 v229, 1, v99
    v_lshlrev_b32 v229, 11, v229
    v_lshl_add_u32 v229, v1, 4, v229
    ds_write_b128 v229, v[232:235] offset:5632
    s_mul_i32 s4, s8, 576
    v_lshl_add_u32 v236, v72, 4, s4
    v_lshl_add_u32 v237, v72, 2, s4
    s_mul_i32 s4, s6, 288
    v_lshl_add_u32 v238, v74, 5, s4
    v_lshl_add_u32 v239, v74, 2, s4
    s_mul_i32 s4, s7, 144
    v_lshl_add_u32 v240, v72, 2, s4
    v_bfe_u32 v232, v0, 3, 1
    v_bfe_u32 v233, v0, 5, 1
    v_cmp_eq_u32 vcc, v232, v233
    v_bfe_u32 v232, v0, 4, 1
    v_lshlrev_b32 v232, 7, v232
    v_lshl_add_u32 v232, v233, 8, v232
    v_lshrrev_b32 v233, 2, v73
    v_add_u32 v232, v232, v233
    v_lshl_add_u32 v241, v99, 9, v232
    s_and_b32 s4, s3, 1
    s_lshl_b32 s4, s4, 11
    s_lshr_b32 s5, s3, 1
    s_lshl_b32 s5, s5, 9
    s_add_u32 s4, s4, s5
    s_add_u32 s4, s4, 2048
    v_add_u32 v242, s4, v232
    v_mov_b32 v233, 27136
    v_cndmask_b32 v241, v233, v241, vcc
    v_cndmask_b32 v242, v233, v242, vcc
    v_mov_b32 v233, 20992
    v_lshl_add_u32 v243, v99, 9, v232
    v_cndmask_b32 v243, v233, v243, vcc
    v_lshlrev_b32 v244, 5, v0
    v_min_u32 v244, 2304, v244
    s_waitcnt vmcnt(6)
    v_perm_b32 v72, v24, v24, s32
    v_perm_b32 v73, v24, v24, s63
    v_perm_b32 v74, v25, v25, s32
    v_perm_b32 v75, v25, v25, s63
    v_perm_b32 v76, v26, v26, s32
    v_perm_b32 v77, v26, v26, s63
    v_perm_b32 v78, v27, v27, s32
    v_perm_b32 v79, v27, v27, s63
    ds_write_b128 v244, v[72:75] offset:0
    ds_write_b128 v244, v[76:79] offset:16
    s_addk_i32 s14, 9216
    buffer_load_dwordx4 v[140:143], v12, s[68:71], s14 offen nt
    s_addk_i32 s14, 9216
    buffer_load_dwordx4 v[144:147], v12, s[68:71], s14 offen nt
    s_addk_i32 s14, 9216
    buffer_load_dwordx4 v[148:151], v12, s[68:71], s14 offen nt
    buffer_load_dwordx4 v[152:155], v15, s[68:71], 0 offen nt
    buffer_load_dwordx4 v[156:159], v16, s[76:79], 0 offen nt
    s_waitcnt lgkmcnt(0)
    s_barrier
    ds_read_b128 v[32:35], v236 offset:0
    ds_read_b32 v36, v237 offset:512
    ds_read_b128 v[40:43], v238 offset:0
    ds_read_b128 v[44:47], v238 offset:16
    ds_read_b32 v37, v239 offset:256
    ds_read_b32 v38, v240 offset:0
    ds_read_b32 v39, v240 offset:128
    s_add_u32 s62, s62, 1
    s_and_b32 s63, s62, 0x3ff
    s_and_b32 s62, s62, 0xff
    s_getreg_b32 s100, hwreg(HW_REG_XCC_ID, 0, 4)
    s_lshl_b32 s100, s100, 8
    s_add_u32 s100, s100, s62
    s_waitcnt lgkmcnt(5)
    v_and_b32 v72, v32, v2
    v_and_b32 v73, v32, v3
    v_and_b32 v74, v32, v4
    v_and_b32 v75, v32, v5
    s_nop 1
    v_mfma_f32_16x16x32_bf16 v[52:55], v[100:103], v[72:75], 0
    v_and_b32 v76, v33, v2
    v_and_b32 v77, v33, v3
    v_and_b32 v78, v33, v4
    v_and_b32 v79, v33, v5
    s_nop 1
    v_mfma_f32_16x16x32_bf16 v[52:55], v[104:107], v[76:79], v[52:55]
    v_and_b32 v80, v34, v2
    v_and_b32 v81, v34, v3
    v_and_b32 v82, v34, v4
    v_and_b32 v83, v34, v5
    s_nop 1
    v_mfma_f32_16x16x32_bf16 v[52:55], v[108:111], v[80:83], v[52:55]
    v_and_b32 v84, v35, v2
    v_and_b32 v85, v35, v3
    v_and_b32 v86, v35, v4
    v_and_b32 v87, v35, v5
    s_nop 1
    v_mfma_f32_16x16x32_bf16 v[52:55], v[112:115], v[84:87], v[52:55]
    v_and_b32 v72, v36, v2
    v_and_b32 v73, v36, v3
    v_and_b32 v74, v36, v4
    v_and_b32 v75, v36, v5
    s_nop 1
    v_mfma_f32_16x16x32_bf16 v[52:55], v[116:119], v[72:75], v[52:55]
    s_waitcnt vmcnt(8)
    v_lshlrev_b32 v228, 16, v24
    v_and_b32 v229, 0xffff0000, v24
    v_lshlrev_b32 v230, 16, v28
    v_and_b32 v231, 0xffff0000, v28
    v_pk_mul_f32 v[228:229], v[228:229], v[230:231]
    v_cvt_pk_bf16_f32 v228, v228, v229
    v_and_b32 v229, 0xffff0000, v228
    v_lshlrev_b32 v228, 16, v228
    v_pk_mul_f32 v[232:233], v[228:229], 1.0 op_sel_hi:[1,0]
    v_lshlrev_b32 v228, 16, v25
    v_and_b32 v229, 0xffff0000, v25
    v_lshlrev_b32 v230, 16, v29
    v_and_b32 v231, 0xffff0000, v29
    v_pk_mul_f32 v[228:229], v[228:229], v[230:231]
    v_cvt_pk_bf16_f32 v228, v228, v229
    v_and_b32 v229, 0xffff0000, v228
    v_lshlrev_b32 v228, 16, v228
    v_pk_add_f32 v[232:233], v[232:233], v[228:229]
    v_lshlrev_b32 v228, 16, v26
    v_and_b32 v229, 0xffff0000, v26
    v_lshlrev_b32 v230, 16, v30
    v_and_b32 v231, 0xffff0000, v30
    v_pk_mul_f32 v[228:229], v[228:229], v[230:231]
    v_cvt_pk_bf16_f32 v228, v228, v229
    v_and_b32 v229, 0xffff0000, v228
    v_lshlrev_b32 v228, 16, v228
    v_pk_add_f32 v[232:233], v[232:233], v[228:229]
    v_lshlrev_b32 v228, 16, v27
    v_and_b32 v229, 0xffff0000, v27
    v_lshlrev_b32 v230, 16, v31
    v_and_b32 v231, 0xffff0000, v31
    v_pk_mul_f32 v[228:229], v[228:229], v[230:231]
    v_cvt_pk_bf16_f32 v228, v228, v229
    v_and_b32 v229, 0xffff0000, v228
    v_lshlrev_b32 v228, 16, v228
    v_pk_add_f32 v[232:233], v[232:233], v[228:229]
    ds_write_b32 v241, v52 offset:2560
    ds_write_b32 v241, v53 offset:2592
    ds_write_b32 v241, v54 offset:2624
    ds_write_b32 v241, v55 offset:2656
    v_add_f32 v232, v232, v233
    s_nop 1
    v_add_f32_dpp v232, v232, v232 row_ror:1 row_mask:0xf bank_mask:0xf
    s_nop 1
    v_add_f32_dpp v232, v232, v232 row_ror:2 row_mask:0xf bank_mask:0xf
    s_nop 1
    v_add_f32_dpp v232, v232, v232 row_ror:4 row_mask:0xf bank_mask:0xf
    s_nop 1
    v_add_f32_dpp v232, v232, v232 row_ror:8 row_mask:0xf bank_mask:0xf
    v_lshrrev_b32 v229, 4, v0
    v_lshlrev_b32 v229, 2, v229
    ds_write_b32 v229, v232 offset:15104
    s_lshl_b32 s4, s2, 10
    s_add_u32 s4, s4, 4096
    v_lshl_add_u32 v21, v1, 4, s4
    s_waitcnt lgkmcnt(0)
    s_barrier
    s_cmp_lg_u32 s3, 3
    s_cbranch_scc1 L_qpub1
    s_mov_b32 exec_lo, 0xffff
    s_mov_b32 exec_hi, 0x0
    v_lshrrev_b32 v228, 4, v1
    v_lshlrev_b32 v228, 11, v228
    v_and_b32 v229, 15, v1
    v_lshl_add_u32 v228, v229, 4, v228
    ds_read_b128 v[64:67], v228 offset:2560
    ds_read_b128 v[68:71], v228 offset:2816
    ds_read_b128 v[48:51], v228 offset:3072
    ds_read_b128 v[92:95], v228 offset:3328
    ds_read_b128 v[232:235], v228 offset:3584
    ds_read_b128 v[236:239], v228 offset:3840
    ds_read_b128 v[248:251], v228 offset:4096
    ds_read_b128 v[252:255], v228 offset:4352
    s_waitcnt lgkmcnt(0)
    v_pk_add_f32 v[64:65], v[64:65], v[68:69]
    v_pk_add_f32 v[66:67], v[66:67], v[70:71]
    v_pk_add_f32 v[64:65], v[64:65], v[48:49]
    v_pk_add_f32 v[66:67], v[66:67], v[50:51]
    v_pk_add_f32 v[64:65], v[64:65], v[92:93]
    v_pk_add_f32 v[66:67], v[66:67], v[94:95]
    v_pk_add_f32 v[64:65], v[64:65], v[232:233]
    v_pk_add_f32 v[66:67], v[66:67], v[234:235]
    v_pk_add_f32 v[64:65], v[64:65], v[236:237]
    v_pk_add_f32 v[66:67], v[66:67], v[238:239]
    v_pk_add_f32 v[64:65], v[64:65], v[248:249]
    v_pk_add_f32 v[66:67], v[66:67], v[250:251]
    v_pk_add_f32 v[64:65], v[64:65], v[252:253]
    v_pk_add_f32 v[66:67], v[66:67], v[254:255]
    v_and_or_b32 v64, v64, v17, s62
    v_and_or_b32 v65, v65, v17, s62
    v_and_or_b32 v66, v66, v17, s62
    v_and_or_b32 v67, v67, v17, s62
    s_mov_b64 exec, 1
    v_and_b32 v64, 0xfffff000, v64
    v_or_b32 v64, s100, v64
    s_mov_b64 exec, 0xffff
    s_branch L_qpub1s
L_qpub1:
    s_mov_b64 exec, 0
L_qpub1s:
    buffer_store_dwordx4 v[64:67], v21, s[96:99], 0 offen sc1
    s_mov_b64 exec, -1
    v_and_b32 v76, v40, v2
    v_and_b32 v77, v40, v3
    v_and_b32 v78, v40, v4
    v_and_b32 v79, v40, v5
    s_waitcnt vmcnt(11)
    s_nop 0
    v_mfma_f32_16x16x32_bf16 v[56:59], v[120:123], v[76:79], 0
    buffer_load_dwordx4 v[160:163], v18, s[76:79], 0 offen nt
    v_and_b32 v80, v41, v2
    v_and_b32 v81, v41, v3
    v_and_b32 v82, v41, v4
    v_and_b32 v83, v41, v5
    s_waitcnt vmcnt(11)
    s_nop 0
    v_mfma_f32_16x16x32_bf16 v[56:59], v[124:127], v[80:83], v[56:59]
    s_lshl_b32 s13, s9, 12
    buffer_load_dwordx4 v[164:167], v13, s[72:75], s13 offen nt
    v_and_b32 v84, v42, v2
    v_and_b32 v85, v42, v3
    v_and_b32 v86, v42, v4
    v_and_b32 v87, v42, v5
    s_waitcnt vmcnt(10)
    s_nop 0
    v_mfma_f32_16x16x32_bf16 v[56:59], v[128:131], v[84:87], v[56:59]
    s_addk_i32 s13, 4096
    s_bitset0_b32 s13, 16
    buffer_load_dwordx4 v[168:171], v13, s[72:75], s13 offen nt
    v_mov_b32 v228, 0
    ds_read_b128 v[232:235], v228 offset:15104
    ds_read_b32 v236, v228 offset:15120
    s_waitcnt lgkmcnt(0)
    v_pk_add_f32 v[232:233], v[232:233], v[234:235]
    v_add_f32 v228, v232, v233
    v_add_f32 v228, v228, v236
    v_cvt_pk_bf16_f32 v228, v228, v228
    v_lshlrev_b32 v228, 16, v228
    v_mul_f32 v228, 0xbfb8aa3b, v228
    v_exp_f32 v228, v228
    s_nop 0
    v_add_f32 v228, 1.0, v228
    v_rcp_f32 v228, v228
    s_nop 0
    v_cvt_pk_bf16_f32 v228, v228, v228
    v_lshlrev_b32 v97, 16, v228
    v_sub_f32 v228, 1.0, v97
    v_cvt_pk_bf16_f32 v228, v228, v228
    v_lshlrev_b32 v98, 16, v228
    v_and_b32 v72, v43, v2
    v_and_b32 v73, v43, v3
    v_and_b32 v74, v43, v4
    v_and_b32 v75, v43, v5
    s_waitcnt vmcnt(10)
    s_nop 0
    v_mfma_f32_16x16x32_bf16 v[56:59], v[132:135], v[72:75], v[56:59]
    s_addk_i32 s13, 4096
    s_bitset0_b32 s13, 16
    buffer_load_dwordx4 v[172:175], v13, s[72:75], s13 offen nt
    v_and_b32 v76, v44, v2
    v_and_b32 v77, v44, v3
    v_and_b32 v78, v44, v4
    v_and_b32 v79, v44, v5
    s_waitcnt vmcnt(10)
    s_nop 0
    v_mfma_f32_16x16x32_bf16 v[56:59], v[136:139], v[76:79], v[56:59]
    s_addk_i32 s13, 4096
    s_bitset0_b32 s13, 16
    buffer_load_dwordx4 v[176:179], v13, s[72:75], s13 offen nt
    v_and_b32 v80, v45, v2
    v_and_b32 v81, v45, v3
    v_and_b32 v82, v45, v4
    v_and_b32 v83, v45, v5
    s_waitcnt vmcnt(10)
    s_nop 0
    v_mfma_f32_16x16x32_bf16 v[56:59], v[140:143], v[80:83], v[56:59]
    s_addk_i32 s13, 4096
    s_bitset0_b32 s13, 16
    buffer_load_dwordx4 v[180:183], v13, s[72:75], s13 offen nt
    s_lshl_b32 s4, s3, 16
    s_lshl_b32 s5, s9, 12
    s_add_u32 s4, s4, s5
    s_add_u32 s4, s4, 4096
    v_lshrrev_b32 v228, 4, v1
    v_lshlrev_b32 v228, 10, v228
    v_and_b32 v229, 15, v1
    v_lshl_add_u32 v228, v229, 4, v228
    v_add_u32 v10, s4, v228
    s_xor_b32 s5, s9, 1
    s_lshl_b32 s5, s5, 12
    s_add_u32 s5, s5, 4096
    v_bfe_u32 v228, v0, 2, 2
    v_lshlrev_b32 v228, 16, v228
    v_and_b32 v229, 3, v0
    v_lshl_add_u32 v228, v229, 10, v228
    v_add_u32 v11, s5, v228
    v_and_b32 v84, v46, v2
    v_and_b32 v85, v46, v3
    v_and_b32 v86, v46, v4
    v_and_b32 v87, v46, v5
    s_waitcnt vmcnt(10)
    s_nop 0
    v_mfma_f32_16x16x32_bf16 v[56:59], v[144:147], v[84:87], v[56:59]
    s_addk_i32 s13, 4096
    s_bitset0_b32 s13, 16
    buffer_load_dwordx4 v[184:187], v13, s[72:75], s13 offen nt
    v_and_b32 v72, v47, v2
    v_and_b32 v73, v47, v3
    v_and_b32 v74, v47, v4
    v_and_b32 v75, v47, v5
    s_waitcnt vmcnt(10)
    s_nop 0
    v_mfma_f32_16x16x32_bf16 v[56:59], v[148:151], v[72:75], v[56:59]
    s_addk_i32 s13, 4096
    s_bitset0_b32 s13, 16
    buffer_load_dwordx4 v[188:191], v13, s[72:75], s13 offen nt
    v_and_b32 v76, v37, v2
    v_and_b32 v77, v37, v3
    v_and_b32 v78, v37, v4
    v_and_b32 v79, v37, v5
    s_waitcnt vmcnt(10)
    s_nop 0
    v_mfma_f32_16x16x32_bf16 v[56:59], v[152:155], v[76:79], v[56:59]
    s_addk_i32 s13, 4096
    s_bitset0_b32 s13, 16
    buffer_load_dwordx4 v[192:195], v13, s[72:75], s13 offen nt
    v_and_b32 v80, v38, v2
    v_and_b32 v81, v38, v3
    v_and_b32 v82, v38, v4
    v_and_b32 v83, v38, v5
    s_waitcnt vmcnt(10)
    s_nop 0
    v_mfma_f32_16x16x32_bf16 v[60:63], v[156:159], v[80:83], 0
    s_addk_i32 s13, 4096
    s_bitset0_b32 s13, 16
    buffer_load_dwordx4 v[196:199], v13, s[72:75], s13 offen nt
    v_and_b32 v84, v39, v2
    v_and_b32 v85, v39, v3
    v_and_b32 v86, v39, v4
    v_and_b32 v87, v39, v5
    s_waitcnt vmcnt(9)
    s_nop 0
    v_mfma_f32_16x16x32_bf16 v[60:63], v[160:163], v[84:87], v[60:63]
    s_addk_i32 s13, 4096
    s_bitset0_b32 s13, 16
    buffer_load_dwordx4 v[200:203], v13, s[72:75], s13 offen nt
    ds_write_b32 v242, v56 offset:2560
    ds_write_b32 v242, v57 offset:2592
    ds_write_b32 v242, v58 offset:2624
    ds_write_b32 v242, v59 offset:2656
    v_mul_u32_u24 v22, 1639, v0
    v_lshrrev_b32 v22, 16, v22
    v_mul_u32_u24 v96, 40, v22
    v_sub_u32 v96, v0, v96
    v_mul_u32_u24 v18, 6912, v22
    v_lshl_add_u32 v18, v96, 4, v18
    v_add_u32 v12, 4608, v18
    ds_write_b32 v243, v60 offset:8704
    ds_write_b32 v243, v61 offset:8736
    ds_write_b32 v243, v62 offset:8768
    ds_write_b32 v243, v63 offset:8800
    s_bfe_u32 s4, s2, 0x10006
    s_lshl1_add_u32 s4, s11, s4
    s_mul_i32 s4, s4, 36864
    v_add_u32 v15, s4, v18
    s_lshr_b32 s5, s11, 3
    s_lshl_b32 s5, s5, 4
    s_and_b32 s6, s11, 7
    s_add_u32 s5, s5, s6
    s_bfe_u32 s6, s2, 0x10006
    s_lshl3_add_u32 s5, s6, s5
    s_mul_i32 s5, s5, 4608
    s_add_u32 s5, s5, 4716288
    v_lshl_add_u32 v16, v96, 4, s5
    v_cmp_gt_u32 vcc, 5, v22
    v_cmp_gt_u32 s[4:5], 6, v22
    v_bfrev_b32 v228, -2
    v_cndmask_b32 v16, v16, v15, vcc
    v_cndmask_b32 v15, v228, v15, s[4:5]
    v_cndmask_b32 v16, v228, v16, s[4:5]
    s_lshr_b32 s4, s2, 7
    s_lshl_b32 s4, s4, 3
    s_sub_u32 s4, 40, s4
    v_cmp_gt_u32 vcc, s4, v96
    s_lshl_b32 s14, s4, 1
    s_nop 0
    v_cndmask_b32 v15, v228, v15, vcc
    v_cndmask_b32 v16, v228, v16, vcc
    v_cndmask_b32 v18, v228, v18, vcc
    v_cndmask_b32 v12, v228, v12, vcc
    v_mul_u32_u24 v228, 1280, v22
    v_lshl_add_u32 v96, v96, 5, v228
    v_mul_u32_u24 v22, 12, v22
    v_add_u32 v22, 15616, v22
    s_addk_i32 s13, 4096
    s_bitset0_b32 s13, 16
    buffer_load_dwordx4 v[204:207], v13, s[72:75], s13 offen nt
    s_addk_i32 s13, 4096
    s_bitset0_b32 s13, 16
    buffer_load_dwordx4 v[208:211], v13, s[72:75], s13 offen nt
    s_lshr_b32 s4, s2, 7
    s_mul_i32 s4, s4, 20
    s_mul_i32 s5, s3, 5
    s_add_u32 s4, s4, s5
    s_mul_i32 s4, s4, 8192
    s_and_b32 s5, s2, 127
    s_mul_i32 s5, s5, 64
    s_add_u32 s4, s4, s5
    s_add_u32 s4, s4, 655360
    s_add_u32 s4, s60, s4
    s_addc_u32 s5, s61, 0
    s_load_dword s33, s[4:5], 0
    s_load_dword s33, s[4:5], 8192
    s_load_dword s33, s[4:5], 16384
    s_load_dword s33, s[4:5], 24576
    s_load_dword s33, s[4:5], 32768
    s_waitcnt vmcnt(11)
    s_waitcnt vmcnt(10)
    s_cmp_eq_u32 s3, 0
    s_cselect_b64 exec, 0xffff, 0
    buffer_load_dwordx4 v[64:67], v11, s[96:99], 0 offen sc1
    s_mov_b64 exec, -1
    buffer_load_dwordx4 v[92:95], v10, s[96:99], 0 offen sc1
    s_waitcnt vmcnt(11)
    s_addk_i32 s13, 4096
    s_bitset0_b32 s13, 16
    buffer_load_dwordx4 v[212:215], v13, s[72:75], s13 offen nt
    s_waitcnt vmcnt(11)
    s_addk_i32 s13, 4096
    s_bitset0_b32 s13, 16
    buffer_load_dwordx4 v[216:219], v13, s[72:75], s13 offen nt
    s_waitcnt vmcnt(11)
    s_addk_i32 s13, 4096
    s_bitset0_b32 s13, 16
    buffer_load_dwordx4 v[220:223], v13, s[72:75], s13 offen nt
    s_waitcnt vmcnt(11)
    s_addk_i32 s13, 4096
    s_bitset0_b32 s13, 16
    buffer_load_dwordx4 v[224:227], v13, s[72:75], s13 offen nt
    s_waitcnt vmcnt(11)
    s_lshl_b32 s13, s9, 12
    buffer_load_dwordx4 v[100:103], v14, s[92:95], s13 offen nt
    s_waitcnt vmcnt(11)
    s_addk_i32 s13, 4096
    s_bitset0_b32 s13, 16
    buffer_load_dwordx4 v[104:107], v14, s[92:95], s13 offen nt
    s_waitcnt vmcnt(11)
    s_addk_i32 s13, 4096
    s_bitset0_b32 s13, 16
    buffer_load_dwordx4 v[108:111], v14, s[92:95], s13 offen nt
    s_waitcnt vmcnt(11)
    s_addk_i32 s13, 4096
    s_bitset0_b32 s13, 16
    buffer_load_dwordx4 v[112:115], v14, s[92:95], s13 offen nt
    s_waitcnt vmcnt(11)
    s_addk_i32 s13, 4096
    s_bitset0_b32 s13, 16
    buffer_load_dwordx4 v[116:119], v14, s[92:95], s13 offen nt
    s_waitcnt vmcnt(11)
    s_addk_i32 s13, 4096
    s_bitset0_b32 s13, 16
    buffer_load_dwordx4 v[120:123], v14, s[92:95], s13 offen nt
    s_addk_i32 s13, 4096
    s_bitset0_b32 s13, 16
    buffer_load_dwordx4 v[124:127], v14, s[92:95], s13 offen nt
    s_addk_i32 s13, 4096
    s_bitset0_b32 s13, 16
    buffer_load_dwordx4 v[128:131], v14, s[92:95], s13 offen nt
    v_bfe_u32 v229, v0, 3, 1
    v_lshlrev_b32 v229, 9, v229
    v_bfe_u32 v230, v0, 4, 2
    v_lshl_add_u32 v229, v230, 7, v229
    v_and_b32 v230, 3, v0
    v_lshl_add_u32 v229, v230, 5, v229
    s_waitcnt vmcnt(12)
    s_mov_b32 s7, 20000
L_qre3:
    v_xor_b32 v228, s62, v92
    v_bitop3_b32 v228, v93, s62, v228 bitop3:0xbe
    v_bitop3_b32 v228, v94, s62, v228 bitop3:0xbe
    v_bitop3_b32 v228, v95, s62, v228 bitop3:0xbe
    v_and_b32 v228, 0xff, v228
    v_cmp_ne_u32 vcc, 0, v228
    s_nop 0
    s_cbranch_vccz L_qok2
    buffer_load_dwordx4 v[92:95], v10, s[96:99], 0 offen sc1
    s_waitcnt vmcnt(0)
    s_sub_u32 s7, s7, 1
    s_cmp_lg_u32 s7, 0
    s_cbranch_scc1 L_qre3
L_qok2:
    v_and_b32 v230, 15, v0
    v_cmp_eq_u32 vcc, 0, v230
    v_xor_b32 v228, s100, v92
    s_movk_i32 s4, 0x80
    v_cndmask_b32 v228, 0, v228, vcc
    v_mov_b32 v230, 0x800
    v_mov_b32 v231, 0xfffff000
    v_and_or_b32 v230, v92, v231, v230
    v_and_or_b32 v92, v92, v17, s4
    v_and_or_b32 v93, v93, v17, s4
    v_and_or_b32 v94, v94, v17, s4
    v_and_or_b32 v95, v95, v17, s4
    v_cndmask_b32 v92, v92, v230, vcc
    ds_write_b128 v14, v[92:95] offset:10752
    v_cmp_gt_u32 vcc, 16, v0
    v_xor_b32 v230, s62, v65
    v_bitop3_b32 v230, v66, s62, v230 bitop3:0xbe
    v_bitop3_b32 v230, v67, s62, v230 bitop3:0xbe
    v_and_b32 v230, 0xff, v230
    v_bitop3_b32 v230, v64, s100, v230 bitop3:0xbe
    v_cndmask_b32 v230, 0, v230, vcc
    v_or_b32 v228, v228, v230
    v_and_b32 v228, 0xfff, v228
    v_cmp_ne_u32 vcc, 0, v228
    v_lshlrev_b32 v230, 2, v99
    s_cmp_lg_u64 vcc, 0
    s_cselect_b32 s4, 1, 0
    v_mov_b32 v228, s4
    ds_write_b32 v230, v228 offset:31744
    v_mov_b32 v230, 0
    s_waitcnt lgkmcnt(0)
    s_barrier
    ds_read_b128 v[64:67], v230 offset:31744
    ds_read_b128 v[72:75], v229 offset:10752
    ds_read_b128 v[76:79], v229 offset:10768
    ds_read_b128 v[80:83], v229 offset:11776
    ds_read_b128 v[84:87], v229 offset:11792
    ds_read_b128 v[236:239], v229 offset:12800
    ds_read_b128 v[240:243], v229 offset:12816
    ds_read_b128 v[244:247], v229 offset:13824
    ds_read_b128 v[248:251], v229 offset:13840
    s_waitcnt lgkmcnt(4)
    v_or3_b32 v64, v64, v65, v66
    v_or_b32 v64, v64, v67
    v_pk_add_f32 v[72:73], v[72:73], v[80:81]
    v_pk_add_f32 v[74:75], v[74:75], v[82:83]
    v_pk_add_f32 v[76:77], v[76:77], v[84:85]
    v_pk_add_f32 v[78:79], v[78:79], v[86:87]
    v_cmp_eq_u32 s[34:35], 0, v64
    s_waitcnt lgkmcnt(0)
    v_pk_add_f32 v[236:237], v[236:237], v[244:245]
    v_pk_add_f32 v[238:239], v[238:239], v[246:247]
    v_pk_add_f32 v[240:241], v[240:241], v[248:249]
    v_pk_add_f32 v[242:243], v[242:243], v[250:251]
    v_pk_add_f32 v[72:73], v[72:73], v[236:237]
    v_pk_add_f32 v[74:75], v[74:75], v[238:239]
    v_pk_add_f32 v[76:77], v[76:77], v[240:241]
    v_pk_add_f32 v[78:79], v[78:79], v[242:243]
    v_cvt_pk_bf16_f32 v48, v72, v73
    v_cvt_pk_bf16_f32 v49, v74, v75
    v_cvt_pk_bf16_f32 v50, v76, v77
    v_cvt_pk_bf16_f32 v51, v78, v79
    s_cmp_lg_u32 s3, 2
    s_cbranch_scc1 L_gpub4
    s_mov_b32 exec_lo, 0xffff0000
    s_mov_b32 exec_hi, 0xffffffff
    v_lshrrev_b32 v228, 4, v1
    v_lshlrev_b32 v228, 11, v228
    v_and_b32 v229, 15, v1
    v_lshl_add_u32 v228, v229, 4, v228
    ds_read_b128 v[64:67], v228 offset:2560
    ds_read_b128 v[68:71], v228 offset:2816
    ds_read_b128 v[72:75], v228 offset:3072
    ds_read_b128 v[76:79], v228 offset:3328
    ds_read_b128 v[80:83], v228 offset:3584
    ds_read_b128 v[84:87], v228 offset:3840
    ds_read_b128 v[232:235], v228 offset:4096
    ds_read_b128 v[236:239], v228 offset:4352
    s_waitcnt lgkmcnt(0)
    v_pk_add_f32 v[64:65], v[64:65], v[68:69]
    v_pk_add_f32 v[66:67], v[66:67], v[70:71]
    v_pk_add_f32 v[64:65], v[64:65], v[72:73]
    v_pk_add_f32 v[66:67], v[66:67], v[74:75]
    v_pk_add_f32 v[64:65], v[64:65], v[76:77]
    v_pk_add_f32 v[66:67], v[66:67], v[78:79]
    v_pk_add_f32 v[64:65], v[64:65], v[80:81]
    v_pk_add_f32 v[66:67], v[66:67], v[82:83]
    v_pk_add_f32 v[64:65], v[64:65], v[84:85]
    v_pk_add_f32 v[66:67], v[66:67], v[86:87]
    v_pk_add_f32 v[64:65], v[64:65], v[232:233]
    v_pk_add_f32 v[66:67], v[66:67], v[234:235]
    v_pk_add_f32 v[64:65], v[64:65], v[236:237]
    v_pk_add_f32 v[66:67], v[66:67], v[238:239]
    v_and_or_b32 v64, v64, v17, s62
    v_and_or_b32 v65, v65, v17, s62
    v_and_or_b32 v66, v66, v17, s62
    v_and_or_b32 v67, v67, v17, s62
    s_branch L_gpub4s
L_gpub4:
    s_mov_b64 exec, 0
L_gpub4s:
    s_mov_b64 s[4:5], exec
    s_and_b64 exec, s[4:5], s[34:35]
    buffer_store_dwordx4 v[64:67], v21, s[96:99], 0 offen
    s_andn2_b64 exec, s[4:5], s[34:35]
    buffer_store_dwordx4 v[64:67], v21, s[96:99], 0 offen sc1
    s_mov_b64 exec, -1
    v_mov_b32 v17, 0xfffffc00
    s_mov_b32 s15, 0x3db504f3
    v_mfma_f32_16x16x32_bf16 v[72:75], v[164:167], v[48:51], 0
    v_mfma_f32_16x16x32_bf16 v[76:79], v[168:171], v[48:51], 0
    v_mfma_f32_16x16x32_bf16 v[80:83], v[172:175], v[48:51], 0
    s_nop 5
    v_mov_b32_dpp v32, v72 quad_perm:[0,0,0,0] row_mask:0xf bank_mask:0xf
    v_add_f32_dpp v32, v73, v32 quad_perm:[1,1,1,1] row_mask:0xf bank_mask:0xf
    v_add_f32_dpp v32, v74, v32 quad_perm:[2,2,2,2] row_mask:0xf bank_mask:0xf
    v_add_f32_dpp v32, v75, v32 quad_perm:[3,3,3,3] row_mask:0xf bank_mask:0xf
    v_mfma_f32_16x16x32_bf16 v[84:87], v[176:179], v[48:51], 0
    v_mov_b32_dpp v33, v76 quad_perm:[0,0,0,0] row_mask:0xf bank_mask:0xf
    v_add_f32_dpp v33, v77, v33 quad_perm:[1,1,1,1] row_mask:0xf bank_mask:0xf
    v_add_f32_dpp v33, v78, v33 quad_perm:[2,2,2,2] row_mask:0xf bank_mask:0xf
    v_add_f32_dpp v33, v79, v33 quad_perm:[3,3,3,3] row_mask:0xf bank_mask:0xf
    v_cvt_pk_bf16_f32 v228, v32, v33
    v_lshlrev_b32 v32, 16, v228
    v_and_b32 v33, 0xffff0000, v228
    v_mul_f32 v32, s15, v32
    v_mul_f32 v33, s15, v33
    v_cvt_pk_bf16_f32 v228, v32, v33
    v_lshlrev_b32 v32, 16, v228
    v_and_b32 v33, 0xffff0000, v228
    v_max_f32 v229, v32, v33
    v_mfma_f32_16x16x32_bf16 v[72:75], v[180:183], v[48:51], 0
    v_mov_b32_dpp v34, v80 quad_perm:[0,0,0,0] row_mask:0xf bank_mask:0xf
    v_add_f32_dpp v34, v81, v34 quad_perm:[1,1,1,1] row_mask:0xf bank_mask:0xf
    v_add_f32_dpp v34, v82, v34 quad_perm:[2,2,2,2] row_mask:0xf bank_mask:0xf
    v_add_f32_dpp v34, v83, v34 quad_perm:[3,3,3,3] row_mask:0xf bank_mask:0xf
    v_mfma_f32_16x16x32_bf16 v[76:79], v[184:187], v[48:51], 0
    v_mov_b32_dpp v35, v84 quad_perm:[0,0,0,0] row_mask:0xf bank_mask:0xf
    v_add_f32_dpp v35, v85, v35 quad_perm:[1,1,1,1] row_mask:0xf bank_mask:0xf
    v_add_f32_dpp v35, v86, v35 quad_perm:[2,2,2,2] row_mask:0xf bank_mask:0xf
    v_add_f32_dpp v35, v87, v35 quad_perm:[3,3,3,3] row_mask:0xf bank_mask:0xf
    v_cvt_pk_bf16_f32 v228, v34, v35
    v_lshlrev_b32 v34, 16, v228
    v_and_b32 v35, 0xffff0000, v228
    v_mul_f32 v34, s15, v34
    v_mul_f32 v35, s15, v35
    v_cvt_pk_bf16_f32 v228, v34, v35
    v_lshlrev_b32 v34, 16, v228
    v_and_b32 v35, 0xffff0000, v228
    v_max3_f32 v229, v229, v34, v35
    v_mfma_f32_16x16x32_bf16 v[80:83], v[188:191], v[48:51], 0
    v_mov_b32_dpp v36, v72 quad_perm:[0,0,0,0] row_mask:0xf bank_mask:0xf
    v_add_f32_dpp v36, v73, v36 quad_perm:[1,1,1,1] row_mask:0xf bank_mask:0xf
    v_add_f32_dpp v36, v74, v36 quad_perm:[2,2,2,2] row_mask:0xf bank_mask:0xf
    v_add_f32_dpp v36, v75, v36 quad_perm:[3,3,3,3] row_mask:0xf bank_mask:0xf
    v_mfma_f32_16x16x32_bf16 v[84:87], v[192:195], v[48:51], 0
    v_mov_b32_dpp v37, v76 quad_perm:[0,0,0,0] row_mask:0xf bank_mask:0xf
    v_add_f32_dpp v37, v77, v37 quad_perm:[1,1,1,1] row_mask:0xf bank_mask:0xf
    v_add_f32_dpp v37, v78, v37 quad_perm:[2,2,2,2] row_mask:0xf bank_mask:0xf
    v_add_f32_dpp v37, v79, v37 quad_perm:[3,3,3,3] row_mask:0xf bank_mask:0xf
    v_cvt_pk_bf16_f32 v228, v36, v37
    v_lshlrev_b32 v36, 16, v228
    v_and_b32 v37, 0xffff0000, v228
    v_mul_f32 v36, s15, v36
    v_mul_f32 v37, s15, v37
    v_cvt_pk_bf16_f32 v228, v36, v37
    v_lshlrev_b32 v36, 16, v228
    v_and_b32 v37, 0xffff0000, v228
    v_max3_f32 v229, v229, v36, v37
    v_mfma_f32_16x16x32_bf16 v[72:75], v[196:199], v[48:51], 0
    v_mov_b32_dpp v38, v80 quad_perm:[0,0,0,0] row_mask:0xf bank_mask:0xf
    v_add_f32_dpp v38, v81, v38 quad_perm:[1,1,1,1] row_mask:0xf bank_mask:0xf
    v_add_f32_dpp v38, v82, v38 quad_perm:[2,2,2,2] row_mask:0xf bank_mask:0xf
    v_add_f32_dpp v38, v83, v38 quad_perm:[3,3,3,3] row_mask:0xf bank_mask:0xf
    v_mfma_f32_16x16x32_bf16 v[76:79], v[200:203], v[48:51], 0
    v_mov_b32_dpp v39, v84 quad_perm:[0,0,0,0] row_mask:0xf bank_mask:0xf
    v_add_f32_dpp v39, v85, v39 quad_perm:[1,1,1,1] row_mask:0xf bank_mask:0xf
    v_add_f32_dpp v39, v86, v39 quad_perm:[2,2,2,2] row_mask:0xf bank_mask:0xf
    v_add_f32_dpp v39, v87, v39 quad_perm:[3,3,3,3] row_mask:0xf bank_mask:0xf
    v_cvt_pk_bf16_f32 v228, v38, v39
    v_lshlrev_b32 v38, 16, v228
    v_and_b32 v39, 0xffff0000, v228
    v_mul_f32 v38, s15, v38
    v_mul_f32 v39, s15, v39
    v_cvt_pk_bf16_f32 v228, v38, v39
    v_lshlrev_b32 v38, 16, v228
    v_and_b32 v39, 0xffff0000, v228
    v_max3_f32 v229, v229, v38, v39
    v_mfma_f32_16x16x32_bf16 v[80:83], v[204:207], v[48:51], 0
    v_mov_b32_dpp v40, v72 quad_perm:[0,0,0,0] row_mask:0xf bank_mask:0xf
    v_add_f32_dpp v40, v73, v40 quad_perm:[1,1,1,1] row_mask:0xf bank_mask:0xf
    v_add_f32_dpp v40, v74, v40 quad_perm:[2,2,2,2] row_mask:0xf bank_mask:0xf
    v_add_f32_dpp v40, v75, v40 quad_perm:[3,3,3,3] row_mask:0xf bank_mask:0xf
    v_mfma_f32_16x16x32_bf16 v[84:87], v[208:211], v[48:51], 0
    v_mov_b32_dpp v41, v76 quad_perm:[0,0,0,0] row_mask:0xf bank_mask:0xf
    v_add_f32_dpp v41, v77, v41 quad_perm:[1,1,1,1] row_mask:0xf bank_mask:0xf
    v_add_f32_dpp v41, v78, v41 quad_perm:[2,2,2,2] row_mask:0xf bank_mask:0xf
    v_add_f32_dpp v41, v79, v41 quad_perm:[3,3,3,3] row_mask:0xf bank_mask:0xf
    v_cvt_pk_bf16_f32 v228, v40, v41
    v_lshlrev_b32 v40, 16, v228
    v_and_b32 v41, 0xffff0000, v228
    v_mul_f32 v40, s15, v40
    v_mul_f32 v41, s15, v41
    v_cvt_pk_bf16_f32 v228, v40, v41
    v_lshlrev_b32 v40, 16, v228
    v_and_b32 v41, 0xffff0000, v228
    v_max3_f32 v229, v229, v40, v41
    s_waitcnt vmcnt(13)
    v_mfma_f32_16x16x32_bf16 v[72:75], v[212:215], v[48:51], 0
    v_mov_b32_dpp v42, v80 quad_perm:[0,0,0,0] row_mask:0xf bank_mask:0xf
    v_add_f32_dpp v42, v81, v42 quad_perm:[1,1,1,1] row_mask:0xf bank_mask:0xf
    v_add_f32_dpp v42, v82, v42 quad_perm:[2,2,2,2] row_mask:0xf bank_mask:0xf
    v_add_f32_dpp v42, v83, v42 quad_perm:[3,3,3,3] row_mask:0xf bank_mask:0xf
    s_waitcnt vmcnt(12)
    v_mfma_f32_16x16x32_bf16 v[76:79], v[216:219], v[48:51], 0
    v_mov_b32_dpp v43, v84 quad_perm:[0,0,0,0] row_mask:0xf bank_mask:0xf
    v_add_f32_dpp v43, v85, v43 quad_perm:[1,1,1,1] row_mask:0xf bank_mask:0xf
    v_add_f32_dpp v43, v86, v43 quad_perm:[2,2,2,2] row_mask:0xf bank_mask:0xf
    v_add_f32_dpp v43, v87, v43 quad_perm:[3,3,3,3] row_mask:0xf bank_mask:0xf
    v_cvt_pk_bf16_f32 v228, v42, v43
    v_lshlrev_b32 v42, 16, v228
    v_and_b32 v43, 0xffff0000, v228
    v_mul_f32 v42, s15, v42
    v_mul_f32 v43, s15, v43
    v_cvt_pk_bf16_f32 v228, v42, v43
    v_lshlrev_b32 v42, 16, v228
    v_and_b32 v43, 0xffff0000, v228
    v_max3_f32 v229, v229, v42, v43
    s_waitcnt vmcnt(11)
    v_mfma_f32_16x16x32_bf16 v[80:83], v[220:223], v[48:51], 0
    s_addk_i32 s13, 4096
    s_bitset0_b32 s13, 16
    buffer_load_dwordx4 v[132:135], v14, s[92:95], s13 offen nt
    v_mov_b32_dpp v44, v72 quad_perm:[0,0,0,0] row_mask:0xf bank_mask:0xf
    v_add_f32_dpp v44, v73, v44 quad_perm:[1,1,1,1] row_mask:0xf bank_mask:0xf
    v_add_f32_dpp v44, v74, v44 quad_perm:[2,2,2,2] row_mask:0xf bank_mask:0xf
    v_add_f32_dpp v44, v75, v44 quad_perm:[3,3,3,3] row_mask:0xf bank_mask:0xf
    s_waitcnt vmcnt(11)
    v_mfma_f32_16x16x32_bf16 v[84:87], v[224:227], v[48:51], 0
    s_addk_i32 s13, 4096
    s_bitset0_b32 s13, 16
    buffer_load_dwordx4 v[136:139], v14, s[92:95], s13 offen nt
    v_mov_b32_dpp v45, v76 quad_perm:[0,0,0,0] row_mask:0xf bank_mask:0xf
    v_add_f32_dpp v45, v77, v45 quad_perm:[1,1,1,1] row_mask:0xf bank_mask:0xf
    v_add_f32_dpp v45, v78, v45 quad_perm:[2,2,2,2] row_mask:0xf bank_mask:0xf
    v_add_f32_dpp v45, v79, v45 quad_perm:[3,3,3,3] row_mask:0xf bank_mask:0xf
    v_cvt_pk_bf16_f32 v228, v44, v45
    v_lshlrev_b32 v44, 16, v228
    v_and_b32 v45, 0xffff0000, v228
    v_mul_f32 v44, s15, v44
    v_mul_f32 v45, s15, v45
    v_cvt_pk_bf16_f32 v228, v44, v45
    v_lshlrev_b32 v44, 16, v228
    v_and_b32 v45, 0xffff0000, v228
    v_max3_f32 v229, v229, v44, v45
    s_addk_i32 s13, 4096
    s_bitset0_b32 s13, 16
    buffer_load_dwordx4 v[140:143], v14, s[92:95], s13 offen nt
    s_addk_i32 s13, 4096
    s_bitset0_b32 s13, 16
    buffer_load_dwordx4 v[144:147], v14, s[92:95], s13 offen nt
    s_addk_i32 s13, 4096
    s_bitset0_b32 s13, 16
    buffer_load_dwordx4 v[148:151], v14, s[92:95], s13 offen nt
    v_bfe_u32 v230, v0, 3, 1
    v_lshlrev_b32 v230, 6, v230
    v_lshrrev_b32 v231, 4, v0
    v_lshl_add_u32 v13, v231, 2, v230
    v_mov_b32_dpp v46, v80 quad_perm:[0,0,0,0] row_mask:0xf bank_mask:0xf
    v_add_f32_dpp v46, v81, v46 quad_perm:[1,1,1,1] row_mask:0xf bank_mask:0xf
    v_add_f32_dpp v46, v82, v46 quad_perm:[2,2,2,2] row_mask:0xf bank_mask:0xf
    v_add_f32_dpp v46, v83, v46 quad_perm:[3,3,3,3] row_mask:0xf bank_mask:0xf
    v_mov_b32_dpp v47, v84 quad_perm:[0,0,0,0] row_mask:0xf bank_mask:0xf
    v_add_f32_dpp v47, v85, v47 quad_perm:[1,1,1,1] row_mask:0xf bank_mask:0xf
    v_add_f32_dpp v47, v86, v47 quad_perm:[2,2,2,2] row_mask:0xf bank_mask:0xf
    v_add_f32_dpp v47, v87, v47 quad_perm:[3,3,3,3] row_mask:0xf bank_mask:0xf
    v_cvt_pk_bf16_f32 v228, v46, v47
    v_lshlrev_b32 v46, 16, v228
    v_and_b32 v47, 0xffff0000, v228
    v_mul_f32 v46, s15, v46
    v_mul_f32 v47, s15, v47
    v_cvt_pk_bf16_f32 v228, v46, v47
    v_lshlrev_b32 v46, 16, v228
    v_and_b32 v47, 0xffff0000, v228
    v_max3_f32 v229, v229, v46, v47
    ds_write_b32 v13, v229 offset:14848
    s_mov_b32 s15, 0x3fb8aa3b
    s_waitcnt lgkmcnt(0)
    s_barrier
    ds_read_b128 v[72:75], v230 offset:14848
    ds_read_b128 v[76:79], v230 offset:14864
    ds_read_b128 v[80:83], v230 offset:14880
    ds_read_b128 v[84:87], v230 offset:14896
    s_waitcnt lgkmcnt(0)
    v_max3_f32 v72, v72, v73, v74
    v_max3_f32 v72, v72, v75, v76
    v_max3_f32 v72, v72, v77, v78
    v_max3_f32 v72, v72, v79, v80
    v_max3_f32 v72, v72, v81, v82
    v_max3_f32 v72, v72, v83, v84
    v_max3_f32 v72, v72, v85, v86
    v_max_f32 v19, v72, v87
    v_and_b32 v19, v19, v17
    v_mul_f32 v20, s15, v19
    v_fma_f32 v32, v32, s15, -v20
    v_fma_f32 v33, v33, s15, -v20
    v_fma_f32 v34, v34, s15, -v20
    v_fma_f32 v35, v35, s15, -v20
    v_fma_f32 v36, v36, s15, -v20
    v_fma_f32 v37, v37, s15, -v20
    v_fma_f32 v38, v38, s15, -v20
    v_fma_f32 v39, v39, s15, -v20
    v_fma_f32 v40, v40, s15, -v20
    v_fma_f32 v41, v41, s15, -v20
    v_fma_f32 v42, v42, s15, -v20
    v_fma_f32 v43, v43, s15, -v20
    v_fma_f32 v44, v44, s15, -v20
    v_fma_f32 v45, v45, s15, -v20
    v_fma_f32 v46, v46, s15, -v20
    v_fma_f32 v47, v47, s15, -v20
    v_exp_f32 v32, v32
    v_exp_f32 v33, v33
    v_exp_f32 v34, v34
    v_exp_f32 v35, v35
    v_exp_f32 v36, v36
    v_exp_f32 v37, v37
    v_exp_f32 v38, v38
    v_exp_f32 v39, v39
    v_exp_f32 v40, v40
    v_exp_f32 v41, v41
    v_exp_f32 v42, v42
    v_exp_f32 v43, v43
    v_exp_f32 v44, v44
    v_exp_f32 v45, v45
    v_exp_f32 v46, v46
    v_exp_f32 v47, v47
    v_pk_add_f32 v[72:73], v[32:33], v[34:35]
    v_pk_add_f32 v[72:73], v[72:73], v[36:37]
    v_pk_add_f32 v[72:73], v[72:73], v[38:39]
    v_pk_add_f32 v[72:73], v[72:73], v[40:41]
    v_pk_add_f32 v[72:73], v[72:73], v[42:43]
    v_pk_add_f32 v[72:73], v[72:73], v[44:45]
    v_pk_add_f32 v[72:73], v[72:73], v[46:47]
    v_add_f32 v72, v72, v73
    ds_write_b32 v13, v72 offset:14976
    s_cmp_lg_u32 s3, 3
    s_cbranch_scc1 L_haddr5
    s_bfe_u32 s4, s2, 0x10006
    s_lshl_b32 s4, s4, 7
    s_add_u32 s4, s4, 4352
    v_and_b32 v228, 3, v0
    v_lshlrev_b32 v228, 16, v228
    v_bfe_u32 v229, v0, 5, 1
    v_lshl_add_u32 v228, v229, 8, v228
    v_add_u32 v229, 1, v229
    v_xor_b32 v229, s11, v229
    v_lshl_add_u32 v228, v229, 10, v228
    v_bfe_u32 v229, v0, 2, 3
    v_lshl_add_u32 v228, v229, 4, v228
    v_add_u32 v10, s4, v228
    s_and_b32 s4, s11, 0x38
    s_lshl_b32 s4, s4, 10
    s_and_b32 s5, s11, 7
    s_bfe_u32 s6, s2, 0x10006
    s_lshl3_add_u32 s5, s6, s5
    s_lshl_b32 s5, s5, 4
    s_add_u32 s4, s4, s5
    s_add_u32 s4, s4, 4864
    v_bfe_u32 v228, v0, 2, 2
    v_lshlrev_b32 v228, 16, v228
    v_and_b32 v229, 3, v0
    v_lshl_add_u32 v228, v229, 11, v228
    v_bfe_u32 v229, v0, 4, 1
    v_lshl_add_u32 v228, v229, 10, v228
    v_add_u32 v11, s4, v228
L_haddr5:
    v_cvt_pk_bf16_f32 v228, v32, v32
    v_and_b32 v72, v228, v2
    v_and_b32 v73, v228, v3
    v_and_b32 v74, v228, v4
    v_and_b32 v75, v228, v5
    s_waitcnt vmcnt(14)
    s_nop 0
    v_mfma_f32_16x16x32_bf16 v[52:55], v[100:103], v[72:75], 0
    v_cvt_pk_bf16_f32 v228, v33, v33
    v_and_b32 v76, v228, v2
    v_and_b32 v77, v228, v3
    v_and_b32 v78, v228, v4
    v_and_b32 v79, v228, v5
    s_waitcnt vmcnt(13)
    s_nop 0
    v_mfma_f32_16x16x32_bf16 v[52:55], v[104:107], v[76:79], v[52:55]
    v_cvt_pk_bf16_f32 v228, v34, v34
    v_and_b32 v72, v228, v2
    v_and_b32 v73, v228, v3
    v_and_b32 v74, v228, v4
    v_and_b32 v75, v228, v5
    s_waitcnt vmcnt(12)
    s_nop 0
    v_mfma_f32_16x16x32_bf16 v[52:55], v[108:111], v[72:75], v[52:55]
    v_cvt_pk_bf16_f32 v228, v35, v35
    v_and_b32 v76, v228, v2
    v_and_b32 v77, v228, v3
    v_and_b32 v78, v228, v4
    v_and_b32 v79, v228, v5
    s_waitcnt vmcnt(11)
    s_nop 0
    v_mfma_f32_16x16x32_bf16 v[52:55], v[112:115], v[76:79], v[52:55]
    s_addk_i32 s13, 4096
    s_bitset0_b32 s13, 16
    buffer_load_dwordx4 v[152:155], v14, s[92:95], s13 offen nt
    v_bfe_u32 v13, v0, 3, 1
    v_lshlrev_b32 v13, 9, v13
    v_bfe_u32 v229, v0, 4, 2
    v_lshl_add_u32 v13, v229, 7, v13
    v_and_b32 v229, 7, v0
    v_lshl_add_u32 v13, v229, 2, v13
    v_lshl_add_u32 v13, v99, 10, v13
    s_lshl4_add_u32 s6, s9, s10
    s_mul_i32 s6, s6, 1152
    s_add_u32 s6, s6, 327680
    v_lshl_add_u32 v28, v1, 4, s6
    s_mul_i32 s4, s9, 18432
    s_add_u32 s4, s4, 327680
    v_and_b32 v29, 15, v0
    v_mul_u32_u24 v29, 1152, v29
    v_add_u32 v29, s4, v29
    s_and_b32 s5, s10, 7
    s_lshl_b32 s5, s5, 7
    s_lshr_b32 s4, s3, 1
    s_lshl_b32 s4, s4, 6
    s_add_u32 s4, s4, s5
    v_bfe_u32 v229, v0, 4, 2
    v_lshl_add_u32 v30, v229, 4, v29
    v_add_u32 v30, s4, v30
    s_bfe_u32 s4, s10, 0x10002
    s_lshl_b32 s4, s4, 4
    v_add_u32 v29, s4, v29
    v_lshrrev_b32 v21, 2, v0
    v_mul_u32_u24 v21, 8192, v21
    v_and_b32 v229, 3, v0
    v_lshl_add_u32 v21, v229, 4, v21
    s_and_b32 s4, s2, 127
    s_mul_i32 s4, s4, 64
    s_lshr_b32 s5, s2, 7
    s_mul_i32 s5, s5, 163840
    s_add_u32 s4, s4, s5
    s_add_u32 s4, s4, 655360
    v_add_u32 v21, s4, v21
    v_cvt_pk_bf16_f32 v228, v36, v36
    v_and_b32 v72, v228, v2
    v_and_b32 v73, v228, v3
    v_and_b32 v74, v228, v4
    v_and_b32 v75, v228, v5
    s_waitcnt vmcnt(11)
    s_nop 0
    v_mfma_f32_16x16x32_bf16 v[52:55], v[116:119], v[72:75], v[52:55]
    s_addk_i32 s13, 4096
    s_bitset0_b32 s13, 16
    buffer_load_dwordx4 v[156:159], v14, s[92:95], s13 offen nt
    v_subrev_u32 v31, 15616, v22
    v_and_b32 v229, 3, v0
    v_lshlrev_b32 v229, 3, v229
    v_lshl_add_u32 v31, v31, 4, v229
    v_add_u32 v31, 30208, v31
    v_bfe_u32 v229, v0, 2, 2
    s_mov_b32 s4, 0x02020202
    v_mul_lo_u32 v229, v229, s4
    v_add_u32 v229, s32, v229
    v_or_b32 v230, v2, v4
    v_or_b32 v231, v3, v5
    v_mov_b32 v232, 0x0c0c0c0c
    v_bfi_b32 v50, v230, v229, v232
    v_bfi_b32 v51, v231, v229, v232
    s_lshr_b32 s5, s3, 1
    s_lshl_b32 s5, s5, 9
    s_add_u32 s5, s5, 30208
    v_lshl_add_u32 v27, v1, 3, s5
    v_cvt_pk_bf16_f32 v228, v37, v37
    v_and_b32 v76, v228, v2
    v_and_b32 v77, v228, v3
    v_and_b32 v78, v228, v4
    v_and_b32 v79, v228, v5
    s_waitcnt vmcnt(11)
    s_nop 0
    v_mfma_f32_16x16x32_bf16 v[52:55], v[120:123], v[76:79], v[52:55]
    s_addk_i32 s13, 4096
    s_bitset0_b32 s13, 16
    buffer_load_dwordx4 v[160:163], v14, s[92:95], s13 offen nt
    s_cmp_eq_u32 s3, 3
    s_cselect_b64 exec, -1, 0
    buffer_load_dwordx4 v[64:67], v10, s[96:99], 0 offen sc1
    buffer_load_dwordx4 v[68:71], v11, s[96:99], 0 offen sc1
    s_mov_b64 exec, -1
    v_cvt_pk_bf16_f32 v228, v38, v38
    v_and_b32 v72, v228, v2
    v_and_b32 v73, v228, v3
    v_and_b32 v74, v228, v4
    v_and_b32 v75, v228, v5
    s_waitcnt vmcnt(13)
    s_nop 0
    v_mfma_f32_16x16x32_bf16 v[52:55], v[124:127], v[72:75], v[52:55]
    buffer_load_dwordx4 v[188:191], v18, s[84:87], 0 offen offset:0 nt
    v_cvt_pk_bf16_f32 v228, v39, v39
    v_and_b32 v76, v228, v2
    v_and_b32 v77, v228, v3
    v_and_b32 v78, v228, v4
    v_and_b32 v79, v228, v5
    s_waitcnt vmcnt(13)
    s_nop 0
    v_mfma_f32_16x16x32_bf16 v[52:55], v[128:131], v[76:79], v[52:55]
    buffer_load_dwordx4 v[192:195], v18, s[84:87], 0 offen offset:1152 nt
    v_cvt_pk_bf16_f32 v228, v40, v40
    v_and_b32 v72, v228, v2
    v_and_b32 v73, v228, v3
    v_and_b32 v74, v228, v4
    v_and_b32 v75, v228, v5
    s_waitcnt vmcnt(11)
    s_nop 0
    v_mfma_f32_16x16x32_bf16 v[52:55], v[132:135], v[72:75], v[52:55]
    buffer_load_dwordx4 v[196:199], v18, s[84:87], 0 offen offset:2304 nt
    v_cvt_pk_bf16_f32 v228, v41, v41
    v_and_b32 v76, v228, v2
    v_and_b32 v77, v228, v3
    v_and_b32 v78, v228, v4
    v_and_b32 v79, v228, v5
    s_waitcnt vmcnt(11)
    s_nop 0
    v_mfma_f32_16x16x32_bf16 v[52:55], v[136:139], v[76:79], v[52:55]
    buffer_load_dwordx4 v[200:203], v18, s[84:87], 0 offen offset:3456 nt
    v_cvt_pk_bf16_f32 v228, v42, v42
    v_and_b32 v72, v228, v2
    v_and_b32 v73, v228, v3
    v_and_b32 v74, v228, v4
    v_and_b32 v75, v228, v5
    s_waitcnt vmcnt(11)
    s_nop 0
    v_mfma_f32_16x16x32_bf16 v[52:55], v[140:143], v[72:75], v[52:55]
    v_cvt_pk_bf16_f32 v228, v43, v43
    v_and_b32 v76, v228, v2
    v_and_b32 v77, v228, v3
    v_and_b32 v78, v228, v4
    v_and_b32 v79, v228, v5
    s_waitcnt vmcnt(10)
    s_nop 0
    v_mfma_f32_16x16x32_bf16 v[52:55], v[144:147], v[76:79], v[52:55]
    v_cvt_pk_bf16_f32 v228, v44, v44
    v_and_b32 v72, v228, v2
    v_and_b32 v73, v228, v3
    v_and_b32 v74, v228, v4
    v_and_b32 v75, v228, v5
    s_waitcnt vmcnt(9)
    s_nop 0
    v_mfma_f32_16x16x32_bf16 v[52:55], v[148:151], v[72:75], v[52:55]
    v_cvt_pk_bf16_f32 v228, v45, v45
    v_and_b32 v76, v228, v2
    v_and_b32 v77, v228, v3
    v_and_b32 v78, v228, v4
    v_and_b32 v79, v228, v5
    s_waitcnt vmcnt(8)
    s_nop 0
    v_mfma_f32_16x16x32_bf16 v[52:55], v[152:155], v[76:79], v[52:55]
    v_cvt_pk_bf16_f32 v228, v46, v46
    v_and_b32 v72, v228, v2
    v_and_b32 v73, v228, v3
    v_and_b32 v74, v228, v4
    v_and_b32 v75, v228, v5
    s_waitcnt vmcnt(7)
    s_nop 0
    v_mfma_f32_16x16x32_bf16 v[52:55], v[156:159], v[72:75], v[52:55]
    v_cvt_pk_bf16_f32 v228, v47, v47
    v_and_b32 v76, v228, v2
    v_and_b32 v77, v228, v3
    v_and_b32 v78, v228, v4
    v_and_b32 v79, v228, v5
    s_waitcnt vmcnt(6)
    s_nop 0
    v_mfma_f32_16x16x32_bf16 v[52:55], v[160:163], v[76:79], v[52:55]
    s_nop 7
    ds_write_b32 v13, v52 offset:15872
    ds_write_b32 v13, v53 offset:15904
    ds_write_b32 v13, v54 offset:15936
    ds_write_b32 v13, v55 offset:15968
    s_waitcnt lgkmcnt(0)
    s_barrier
    s_cmp_lg_u32 s3, 3
    s_cbranch_scc1 L_hfin6
    s_waitcnt vmcnt(4)
    s_mov_b32 s7, 20000
L_hre8:
    v_xor_b32 v228, s62, v64
    v_bitop3_b32 v228, v65, s62, v228 bitop3:0xbe
    v_bitop3_b32 v228, v66, s62, v228 bitop3:0xbe
    v_bitop3_b32 v228, v67, s62, v228 bitop3:0xbe
    v_bitop3_b32 v228, v68, s62, v228 bitop3:0xbe
    v_bitop3_b32 v228, v69, s62, v228 bitop3:0xbe
    v_bitop3_b32 v228, v70, s62, v228 bitop3:0xbe
    v_bitop3_b32 v228, v71, s62, v228 bitop3:0xbe
    v_and_b32 v228, 0xff, v228
    v_cmp_ne_u32 vcc, 0, v228
    s_nop 0
    s_cbranch_vccz L_hok7
    buffer_load_dwordx4 v[64:67], v10, s[96:99], 0 offen sc1
    buffer_load_dwordx4 v[68:71], v11, s[96:99], 0 offen sc1
    s_waitcnt vmcnt(0)
    s_sub_u32 s7, s7, 1
    s_cmp_lg_u32 s7, 0
    s_cbranch_scc1 L_hre8
L_hok7:
    v_add_f32_dpp v64, v64, v64 quad_perm:[1,0,3,2] row_mask:0xf bank_mask:0xf
    v_add_f32_dpp v65, v65, v65 quad_perm:[1,0,3,2] row_mask:0xf bank_mask:0xf
    v_add_f32_dpp v66, v66, v66 quad_perm:[1,0,3,2] row_mask:0xf bank_mask:0xf
    v_add_f32_dpp v67, v67, v67 quad_perm:[1,0,3,2] row_mask:0xf bank_mask:0xf
    v_add_f32_dpp v68, v68, v68 row_ror:1 row_mask:0xf bank_mask:0xf
    v_add_f32_dpp v69, v69, v69 row_ror:1 row_mask:0xf bank_mask:0xf
    v_add_f32_dpp v70, v70, v70 row_ror:1 row_mask:0xf bank_mask:0xf
    v_add_f32_dpp v71, v71, v71 row_ror:1 row_mask:0xf bank_mask:0xf
    v_add_f32_dpp v64, v64, v64 quad_perm:[2,3,0,1] row_mask:0xf bank_mask:0xf
    v_add_f32_dpp v65, v65, v65 quad_perm:[2,3,0,1] row_mask:0xf bank_mask:0xf
    v_add_f32_dpp v66, v66, v66 quad_perm:[2,3,0,1] row_mask:0xf bank_mask:0xf
    v_add_f32_dpp v67, v67, v67 quad_perm:[2,3,0,1] row_mask:0xf bank_mask:0xf
    v_add_f32_dpp v68, v68, v68 row_ror:2 row_mask:0xf bank_mask:0xf
    v_add_f32_dpp v69, v69, v69 row_ror:2 row_mask:0xf bank_mask:0xf
    v_add_f32_dpp v70, v70, v70 row_ror:2 row_mask:0xf bank_mask:0xf
    v_add_f32_dpp v71, v71, v71 row_ror:2 row_mask:0xf bank_mask:0xf
    v_add_f32_dpp v68, v68, v68 row_ror:4 row_mask:0xf bank_mask:0xf
    v_add_f32_dpp v69, v69, v69 row_ror:4 row_mask:0xf bank_mask:0xf
    v_add_f32_dpp v70, v70, v70 row_ror:4 row_mask:0xf bank_mask:0xf
    v_add_f32_dpp v71, v71, v71 row_ror:4 row_mask:0xf bank_mask:0xf
    v_add_f32_dpp v68, v68, v68 row_ror:8 row_mask:0xf bank_mask:0xf
    v_add_f32_dpp v69, v69, v69 row_ror:8 row_mask:0xf bank_mask:0xf
    v_add_f32_dpp v70, v70, v70 row_ror:8 row_mask:0xf bank_mask:0xf
    v_add_f32_dpp v71, v71, v71 row_ror:8 row_mask:0xf bank_mask:0xf
    v_bfe_u32 v229, v0, 5, 1
    v_mul_u32_u24 v229, 192, v229
    v_bfe_u32 v230, v0, 2, 3
    v_lshl_add_u32 v229, v230, 4, v229
    ds_write_b128 v229, v[64:67] offset:15232
    v_bfe_u32 v229, v0, 4, 1
    v_mul_u32_u24 v229, 192, v229
    ds_write_b128 v229, v[68:71] offset:15360
    v_min_u32 v229, 35, v1
    v_lshlrev_b32 v230, 2, v229
    v_add_u32 v230, 15232, v230
    s_waitcnt lgkmcnt(0)
    ds_read2_b32 v[232:233], v230 offset0:0 offset1:48
    v_lshlrev_b32 v229, 1, v229
    s_waitcnt lgkmcnt(0)
    v_cvt_pk_bf16_f32 v232, v232, v233
    v_and_b32 v233, 0xffff0000, v232
    v_lshlrev_b32 v232, 16, v232
    v_max_f32 v232, 0, v232
    v_mul_f32 v232, v232, v233
    v_add_f32 v232, 0, v232
    v_cvt_pk_bf16_f32 v232, v232, v232
    ds_write_b16 v229, v232 offset:15616
L_hfin6:
    s_cmp_eq_u32 s3, 2
    s_cbranch_scc1 L_mlpub10
    s_cmp_lg_u32 s3, 0
    s_cbranch_scc1 L_opub9
    ds_read_b128 v[72:75], v14 offset:15872
    ds_read_b128 v[76:79], v14 offset:16896
    ds_read_b128 v[80:83], v14 offset:17920
    ds_read_b128 v[84:87], v14 offset:18944
    s_waitcnt lgkmcnt(2)
    v_pk_add_f32 v[72:73], v[72:73], v[76:77]
    v_pk_add_f32 v[74:75], v[74:75], v[78:79]
    s_waitcnt lgkmcnt(0)
    v_pk_add_f32 v[80:81], v[80:81], v[84:85]
    v_pk_add_f32 v[82:83], v[82:83], v[86:87]
    v_pk_add_f32 v[72:73], v[72:73], v[80:81]
    v_pk_add_f32 v[74:75], v[74:75], v[82:83]
    s_branch L_opub9t
L_mlpub10:
    v_bfe_u32 v229, v0, 3, 1
    v_lshlrev_b32 v229, 6, v229
    ds_read_b128 v[232:235], v229 offset:14976
    ds_read_b128 v[236:239], v229 offset:14992
    ds_read_b128 v[240:243], v229 offset:15008
    ds_read_b128 v[244:247], v229 offset:15024
    v_lshrrev_b32 v229, 2, v229
    v_add_u32 v28, s6, v229
    v_add_u32 v28, 1024, v28
    s_waitcnt lgkmcnt(0)
    v_pk_add_f32 v[232:233], v[232:233], v[236:237]
    v_pk_add_f32 v[234:235], v[234:235], v[238:239]
    v_pk_add_f32 v[240:241], v[240:241], v[244:245]
    v_pk_add_f32 v[242:243], v[242:243], v[246:247]
    v_pk_add_f32 v[232:233], v[232:233], v[240:241]
    v_pk_add_f32 v[234:235], v[234:235], v[242:243]
    v_pk_add_f32 v[232:233], v[232:233], v[234:235]
    v_add_f32 v73, v232, v233
    v_mov_b32 v72, v19
    v_mov_b32 v74, v19
    v_mov_b32 v75, v73
    s_mov_b64 exec, 0x101
L_opub9t:
    v_and_or_b32 v72, v72, v17, s63
    v_and_or_b32 v73, v73, v17, s63
    v_and_or_b32 v74, v74, v17, s63
    v_and_or_b32 v75, v75, v17, s63
    s_branch L_opub9s
L_opub9:
    s_mov_b64 exec, 0
L_opub9s:
    s_mov_b64 s[4:5], exec
    s_and_b64 exec, s[4:5], s[34:35]
    buffer_store_dwordx4 v[72:75], v28, s[96:99], 0 offen
    s_andn2_b64 exec, s[4:5], s[34:35]
    buffer_store_dwordx4 v[72:75], v28, s[96:99], 0 offen sc1
    s_mov_b64 exec, -1
    s_waitcnt lgkmcnt(0)
    s_barrier
    s_bitcmp1_b32 s3, 0
    s_cselect_b64 exec, -1, 0
    buffer_load_dwordx4 v[100:103], v30, s[96:99], 0 offen sc1
    buffer_load_dwordx4 v[104:107], v29, s[96:99], 0 offen offset:1024 sc1
    s_mov_b64 exec, -1
    ds_read2_b32 v[24:25], v22 offset0:0 offset1:1
    ds_read_b32 v26, v22 offset:8
    buffer_load_dwordx4 v[204:207], v12, s[84:87], 0 offen offset:0 nt
    buffer_load_dwordx4 v[208:211], v12, s[84:87], 0 offen offset:1152 nt
    v_bfrev_b32 v254, -2
    s_mov_b32 s4, 0xffff
    s_waitcnt lgkmcnt(0)
    v_cmp_ne_u16 s[64:65], 0, v24
    v_cmp_lt_u32 s[66:67], s4, v24
    v_cmp_ne_u16 s[68:69], 0, v25
    v_cmp_lt_u32 s[70:71], s4, v25
    v_cmp_ne_u16 s[72:73], 0, v26
    v_cmp_lt_u32 s[74:75], s4, v26
    v_cndmask_b32 v248, v254, v15, s[64:65]
    v_cndmask_b32 v249, v254, v15, s[66:67]
    v_cndmask_b32 v250, v254, v16, s[68:69]
    v_cndmask_b32 v251, v254, v16, s[70:71]
    v_cndmask_b32 v252, v254, v16, s[72:73]
    v_cndmask_b32 v253, v254, v16, s[74:75]
    buffer_load_dwordx4 v[164:167], v248, s[80:83], 0 offen offset:0 nt
    buffer_load_dwordx4 v[168:171], v249, s[80:83], 0 offen offset:1152 nt
    buffer_load_dwordx4 v[172:175], v250, s[80:83], 0 offen offset:2304 nt
    buffer_load_dwordx4 v[176:179], v251, s[80:83], 0 offen offset:3456 nt
    buffer_load_dwordx4 v[180:183], v252, s[80:83], s12 offen offset:0 nt
    buffer_load_dwordx4 v[184:187], v253, s[80:83], s12 offen offset:1152 nt
    s_waitcnt lgkmcnt(0)
    v_perm_b32 v236, v24, v24, v6
    v_perm_b32 v237, v24, v24, v7
    v_perm_b32 v238, v24, v24, v8
    v_perm_b32 v239, v24, v24, v9
    v_perm_b32 v240, v25, v25, v6
    v_perm_b32 v241, v25, v25, v7
    v_perm_b32 v242, v25, v25, v8
    v_perm_b32 v243, v25, v25, v9
    v_perm_b32 v244, v26, v26, v6
    v_perm_b32 v245, v26, v26, v7
    v_perm_b32 v246, v26, v26, v8
    v_perm_b32 v247, v26, v26, v9
    s_bitcmp0_b32 s3, 0
    s_cbranch_scc1 L_ocons11
    s_waitcnt vmcnt(8)
    v_xor_b32 v232, s63, v100
    v_bitop3_b32 v232, v101, s63, v232 bitop3:0xbe
    v_bitop3_b32 v232, v102, s63, v232 bitop3:0xbe
    v_bitop3_b32 v232, v103, s63, v232 bitop3:0xbe
    v_bitop3_b32 v232, v104, s63, v232 bitop3:0xbe
    v_bitop3_b32 v232, v105, s63, v232 bitop3:0xbe
    v_bitop3_b32 v232, v106, s63, v232 bitop3:0xbe
    v_bitop3_b32 v232, v107, s63, v232 bitop3:0xbe
    v_and_b32 v232, 0x3ff, v232
    v_cmp_ne_u32 vcc, 0, v232
    s_nop 0
    s_cbranch_vccz L_oex12d
    s_mov_b32 s7, 20000
L_oere13:
    s_mov_b64 exec, vcc
    buffer_load_dwordx4 v[100:103], v30, s[96:99], 0 offen sc1
    buffer_load_dwordx4 v[104:107], v29, s[96:99], 0 offen offset:1024 sc1
    s_mov_b64 exec, -1
    s_waitcnt vmcnt(0)
    v_xor_b32 v232, s63, v100
    v_bitop3_b32 v232, v101, s63, v232 bitop3:0xbe
    v_bitop3_b32 v232, v102, s63, v232 bitop3:0xbe
    v_bitop3_b32 v232, v103, s63, v232 bitop3:0xbe
    v_bitop3_b32 v232, v104, s63, v232 bitop3:0xbe
    v_bitop3_b32 v232, v105, s63, v232 bitop3:0xbe
    v_bitop3_b32 v232, v106, s63, v232 bitop3:0xbe
    v_bitop3_b32 v232, v107, s63, v232 bitop3:0xbe
    v_and_b32 v232, 0x3ff, v232
    v_cmp_ne_u32 vcc, 0, v232
    s_nop 0
    s_cbranch_vccz L_oex12
    s_sub_u32 s7, s7, 1
    s_cmp_lg_u32 s7, 0
    s_cbranch_scc1 L_oere13
    s_branch L_oex12
L_oex12d:
L_oex12:
    v_and_b32 v48, v104, v17
    v_mov_b32 v49, v105
    v_pk_mul_f32 v[32:33], v[100:101], v[96:97] op_sel:[0,1] op_sel_hi:[1,1]
    v_pk_mul_f32 v[34:35], v[102:103], v[96:97] op_sel:[0,1] op_sel_hi:[1,1]
    v_max_f32_dpp v232, v48, v48 row_ror:1 row_mask:0xf bank_mask:0xf
    s_nop 1
    v_max_f32_dpp v232, v232, v232 row_ror:2 row_mask:0xf bank_mask:0xf
    s_nop 1
    v_max_f32_dpp v232, v232, v232 row_ror:4 row_mask:0xf bank_mask:0xf
    s_nop 1
    v_max_f32_dpp v232, v232, v232 row_ror:8 row_mask:0xf bank_mask:0xf
    v_sub_f32 v48, v48, v232
    v_mul_f32 v48, s15, v48
    v_exp_f32 v48, v48
    s_nop 0
    v_mul_f32 v36, v48, v49
    v_pk_mul_f32 v[32:33], v[32:33], v[48:49] op_sel_hi:[1,0]
    v_pk_mul_f32 v[34:35], v[34:35], v[48:49] op_sel_hi:[1,0]
    v_add_f32_dpp v36, v36, v36 row_ror:1 row_mask:0xf bank_mask:0xf
    v_add_f32_dpp v32, v32, v32 row_ror:1 row_mask:0xf bank_mask:0xf
    v_add_f32_dpp v33, v33, v33 row_ror:1 row_mask:0xf bank_mask:0xf
    v_add_f32_dpp v34, v34, v34 row_ror:1 row_mask:0xf bank_mask:0xf
    v_add_f32_dpp v35, v35, v35 row_ror:1 row_mask:0xf bank_mask:0xf
    v_add_f32_dpp v36, v36, v36 row_ror:2 row_mask:0xf bank_mask:0xf
    v_add_f32_dpp v32, v32, v32 row_ror:2 row_mask:0xf bank_mask:0xf
    v_add_f32_dpp v33, v33, v33 row_ror:2 row_mask:0xf bank_mask:0xf
    v_add_f32_dpp v34, v34, v34 row_ror:2 row_mask:0xf bank_mask:0xf
    v_add_f32_dpp v35, v35, v35 row_ror:2 row_mask:0xf bank_mask:0xf
    v_add_f32_dpp v36, v36, v36 row_ror:4 row_mask:0xf bank_mask:0xf
    v_add_f32_dpp v32, v32, v32 row_ror:4 row_mask:0xf bank_mask:0xf
    v_add_f32_dpp v33, v33, v33 row_ror:4 row_mask:0xf bank_mask:0xf
    v_add_f32_dpp v34, v34, v34 row_ror:4 row_mask:0xf bank_mask:0xf
    v_add_f32_dpp v35, v35, v35 row_ror:4 row_mask:0xf bank_mask:0xf
    v_add_f32_dpp v36, v36, v36 row_ror:8 row_mask:0xf bank_mask:0xf
    v_add_f32_dpp v32, v32, v32 row_ror:8 row_mask:0xf bank_mask:0xf
    v_add_f32_dpp v33, v33, v33 row_ror:8 row_mask:0xf bank_mask:0xf
    v_rcp_f32 v48, v36
    v_add_f32_dpp v34, v34, v34 row_ror:8 row_mask:0xf bank_mask:0xf
    v_add_f32_dpp v35, v35, v35 row_ror:8 row_mask:0xf bank_mask:0xf
    v_pk_mul_f32 v[32:33], v[32:33], v[48:49] op_sel_hi:[1,0]
    v_pk_mul_f32 v[34:35], v[34:35], v[48:49] op_sel_hi:[1,0]
    v_cvt_pk_bf16_f32 v32, v32, v33
    v_cvt_pk_bf16_f32 v33, v34, v35
    v_perm_b32 v34, v33, v32, v50
    v_perm_b32 v35, v33, v32, v51
    ds_write_b64 v27, v[34:35]
    s_branch L_ocons11x
L_ocons11:
L_ocons11x:
    v_cmp_gt_u32 vcc, s14, v0
    s_waitcnt lgkmcnt(0)
    s_barrier
    ds_read2_b64 v[72:75], v31 offset0:0 offset1:4
    ds_read2_b64 v[76:79], v31 offset0:8 offset1:12
    ds_read2_b64 v[80:83], v31 offset0:16 offset1:20
    s_waitcnt vmcnt(5)
    v_mfma_f32_4x4x4_16b_bf16 v[56:59], v[236:237], v[164:165], 0
    v_mfma_f32_4x4x4_16b_bf16 v[60:63], v[236:237], v[166:167], 0
    s_waitcnt vmcnt(4)
    v_mfma_f32_4x4x4_16b_bf16 v[56:59], v[238:239], v[168:169], v[56:59]
    v_mfma_f32_4x4x4_16b_bf16 v[60:63], v[238:239], v[170:171], v[60:63]
    s_waitcnt vmcnt(3)
    v_mfma_f32_4x4x4_16b_bf16 v[56:59], v[240:241], v[172:173], v[56:59]
    v_mfma_f32_4x4x4_16b_bf16 v[60:63], v[240:241], v[174:175], v[60:63]
    s_waitcnt vmcnt(2)
    v_mfma_f32_4x4x4_16b_bf16 v[56:59], v[242:243], v[176:177], v[56:59]
    v_mfma_f32_4x4x4_16b_bf16 v[60:63], v[242:243], v[178:179], v[60:63]
    s_waitcnt vmcnt(1)
    v_mfma_f32_4x4x4_16b_bf16 v[56:59], v[244:245], v[180:181], v[56:59]
    v_mfma_f32_4x4x4_16b_bf16 v[60:63], v[244:245], v[182:183], v[60:63]
    s_waitcnt vmcnt(0)
    v_mfma_f32_4x4x4_16b_bf16 v[56:59], v[246:247], v[184:185], v[56:59]
    v_mfma_f32_4x4x4_16b_bf16 v[60:63], v[246:247], v[186:187], v[60:63]
    s_waitcnt lgkmcnt(2)
    s_waitcnt vmcnt(15)
    v_mfma_f32_4x4x4_16b_bf16 v[64:67], v[72:73], v[188:189], 0
    v_mfma_f32_4x4x4_16b_bf16 v[68:71], v[72:73], v[190:191], 0
    s_waitcnt vmcnt(14)
    v_mfma_f32_4x4x4_16b_bf16 v[64:67], v[74:75], v[192:193], v[64:67]
    v_mfma_f32_4x4x4_16b_bf16 v[68:71], v[74:75], v[194:195], v[68:71]
    s_waitcnt lgkmcnt(1)
    s_waitcnt vmcnt(13)
    v_mfma_f32_4x4x4_16b_bf16 v[64:67], v[76:77], v[196:197], v[64:67]
    v_mfma_f32_4x4x4_16b_bf16 v[68:71], v[76:77], v[198:199], v[68:71]
    s_waitcnt vmcnt(12)
    v_mfma_f32_4x4x4_16b_bf16 v[64:67], v[78:79], v[200:201], v[64:67]
    v_mfma_f32_4x4x4_16b_bf16 v[68:71], v[78:79], v[202:203], v[68:71]
    v_pk_mul_f32 v[56:57], v[56:57], v[98:99] op_sel_hi:[1,0]
    v_pk_mul_f32 v[58:59], v[58:59], v[98:99] op_sel_hi:[1,0]
    v_pk_mul_f32 v[60:61], v[60:61], v[98:99] op_sel_hi:[1,0]
    v_pk_mul_f32 v[62:63], v[62:63], v[98:99] op_sel_hi:[1,0]
    s_waitcnt lgkmcnt(0)
    s_waitcnt vmcnt(7)
    v_mfma_f32_4x4x4_16b_bf16 v[64:67], v[80:81], v[204:205], v[64:67]
    v_mfma_f32_4x4x4_16b_bf16 v[68:71], v[80:81], v[206:207], v[68:71]
    s_waitcnt vmcnt(6)
    v_mfma_f32_4x4x4_16b_bf16 v[64:67], v[82:83], v[208:209], v[64:67]
    v_mfma_f32_4x4x4_16b_bf16 v[68:71], v[82:83], v[210:211], v[68:71]
    s_nop 3
    v_pk_add_f32 v[56:57], v[56:57], v[64:65]
    v_pk_add_f32 v[58:59], v[58:59], v[66:67]
    v_pk_add_f32 v[60:61], v[60:61], v[68:69]
    v_pk_add_f32 v[62:63], v[62:63], v[70:71]
    ds_write_b128 v96, v[56:59] offset:19968
    ds_write_b128 v96, v[60:63] offset:19984
    s_waitcnt lgkmcnt(0)
    s_barrier
    s_and_saveexec_b64 s[4:5], vcc
    s_cbranch_execz L_fpub14
    ds_read_b128 v[72:75], v14 offset:19968
    ds_read_b128 v[76:79], v14 offset:21248
    ds_read_b128 v[80:83], v14 offset:22528
    ds_read_b128 v[84:87], v14 offset:23808
    ds_read_b128 v[88:91], v14 offset:25088
    ds_read_b128 v[232:235], v14 offset:26368
    s_waitcnt lgkmcnt(4)
    v_pk_add_f32 v[72:73], v[72:73], v[76:77]
    v_pk_add_f32 v[74:75], v[74:75], v[78:79]
    s_waitcnt lgkmcnt(2)
    v_pk_add_f32 v[80:81], v[80:81], v[84:85]
    v_pk_add_f32 v[82:83], v[82:83], v[86:87]
    s_waitcnt lgkmcnt(0)
    v_pk_add_f32 v[88:89], v[88:89], v[232:233]
    v_pk_add_f32 v[90:91], v[90:91], v[234:235]
    v_pk_add_f32 v[72:73], v[72:73], v[80:81]
    v_pk_add_f32 v[74:75], v[74:75], v[82:83]
    v_pk_add_f32 v[72:73], v[72:73], v[88:89]
    v_pk_add_f32 v[74:75], v[74:75], v[90:91]
    v_and_or_b32 v72, v72, v17, s63
    v_and_or_b32 v73, v73, v17, s63
    v_and_or_b32 v74, v74, v17, s63
    v_and_or_b32 v75, v75, v17, s63
    buffer_store_dwordx4 v[72:75], v21, s[96:99], 0 offen sc1
L_fpub14:
    s_mov_b64 exec, s[4:5]
    s_mov_b32 s2, s101
    s_cmpk_ge_u32 s2, 36
    s_cbranch_scc1 L_fin
    s_mul_i32 s4, s2, 8192
    s_add_u32 s4, s4, 655360
    v_and_b32 v10, 15, v0
    v_lshlrev_b32 v10, 6, v10
    v_bfe_u32 v11, v0, 4, 2
    v_lshl_add_u32 v10, v11, 4, v10
    v_lshl_add_u32 v10, v99, 10, v10
    v_add_u32 v10, s4, v10
    s_movk_i32 s33, 0x1000
    buffer_load_dwordx4 v[164:167], v10, s[96:99], 0 offen offset:0 sc1
    buffer_load_dwordx4 v[168:171], v10, s[96:99], s33 offen offset:0 sc1
    v_lshrrev_b32 v228, 4, v0
    v_lshlrev_b32 v228, 4, v228
    s_mov_b32 s88, s56
    s_mov_b32 s89, s57
    s_mul_i32 s4, s2, 32
    v_mov_b32 v230, s63
    v_mov_b32 v231, 0
    v_lshl_add_u32 v229, v0, 3, s4
    s_mov_b32 s7, 20000
L_fre16:
    s_waitcnt vmcnt(0)
    v_xor_b32 v232, s63, v164
    v_bitop3_b32 v232, v165, s63, v232 bitop3:0xbe
    v_bitop3_b32 v232, v166, s63, v232 bitop3:0xbe
    v_bitop3_b32 v232, v167, s63, v232 bitop3:0xbe
    v_and_b32 v232, 0x3ff, v232
    v_xor_b32 v233, s63, v168
    v_bitop3_b32 v233, v169, s63, v233 bitop3:0xbe
    v_bitop3_b32 v233, v170, s63, v233 bitop3:0xbe
    v_bitop3_b32 v233, v171, s63, v233 bitop3:0xbe
    v_and_b32 v233, 0x3ff, v233
    v_cmp_ne_u32 s[64:65], 0, v232
    v_cmp_ne_u32 s[66:67], 0, v233
    s_nop 0
    s_or_b64 s[4:5], s[64:65], s[66:67]
    s_cbranch_scc0 L_fx15
    s_mov_b64 exec, s[64:65]
    buffer_load_dwordx4 v[164:167], v10, s[96:99], 0 offen offset:0 sc1
    s_mov_b64 exec, s[66:67]
    buffer_load_dwordx4 v[168:171], v10, s[96:99], s33 offen offset:0 sc1
    s_mov_b64 exec, -1
    s_sub_u32 s7, s7, 1
    s_cmp_lg_u32 s7, 0
    s_cbranch_scc1 L_fre16
L_fx15:
    v_pk_add_f32 v[32:33], v[164:165], v[168:169]
    v_pk_add_f32 v[34:35], v[166:167], v[170:171]
    s_nop 0
    v_add_f32_dpp v32, v32, v32 row_ror:1 row_mask:0xf bank_mask:0xf
    v_add_f32_dpp v33, v33, v33 row_ror:1 row_mask:0xf bank_mask:0xf
    v_add_f32_dpp v34, v34, v34 row_ror:1 row_mask:0xf bank_mask:0xf
    v_add_f32_dpp v35, v35, v35 row_ror:1 row_mask:0xf bank_mask:0xf
    v_add_f32_dpp v32, v32, v32 row_ror:2 row_mask:0xf bank_mask:0xf
    v_add_f32_dpp v33, v33, v33 row_ror:2 row_mask:0xf bank_mask:0xf
    v_add_f32_dpp v34, v34, v34 row_ror:2 row_mask:0xf bank_mask:0xf
    v_add_f32_dpp v35, v35, v35 row_ror:2 row_mask:0xf bank_mask:0xf
    v_add_f32_dpp v32, v32, v32 row_ror:4 row_mask:0xf bank_mask:0xf
    v_add_f32_dpp v33, v33, v33 row_ror:4 row_mask:0xf bank_mask:0xf
    v_add_f32_dpp v34, v34, v34 row_ror:4 row_mask:0xf bank_mask:0xf
    v_add_f32_dpp v35, v35, v35 row_ror:4 row_mask:0xf bank_mask:0xf
    v_add_f32_dpp v32, v32, v32 row_ror:8 row_mask:0xf bank_mask:0xf
    v_add_f32_dpp v33, v33, v33 row_ror:8 row_mask:0xf bank_mask:0xf
    v_add_f32_dpp v34, v34, v34 row_ror:8 row_mask:0xf bank_mask:0xf
    v_add_f32_dpp v35, v35, v35 row_ror:8 row_mask:0xf bank_mask:0xf
    ds_write_b128 v228, v[32:35] offset:29184
    s_waitcnt lgkmcnt(0)
    s_barrier
    s_cmp_lg_u32 s3, 0
    s_cbranch_scc1 L_fin
    s_mov_b64 exec, 0xffff
    ds_read_b128 v[72:75], v14 offset:29184
    s_waitcnt lgkmcnt(0)
    v_add_f32_dpp v72, v72, v72 row_ror:4 row_mask:0xf bank_mask:0xf
    v_add_f32_dpp v73, v73, v73 row_ror:4 row_mask:0xf bank_mask:0xf
    v_add_f32_dpp v74, v74, v74 row_ror:4 row_mask:0xf bank_mask:0xf
    v_add_f32_dpp v75, v75, v75 row_ror:4 row_mask:0xf bank_mask:0xf
    v_add_f32_dpp v72, v72, v72 row_ror:8 row_mask:0xf bank_mask:0xf
    v_add_f32_dpp v73, v73, v73 row_ror:8 row_mask:0xf bank_mask:0xf
    v_add_f32_dpp v74, v74, v74 row_ror:8 row_mask:0xf bank_mask:0xf
    v_add_f32_dpp v75, v75, v75 row_ror:8 row_mask:0xf bank_mask:0xf
    v_cvt_pk_bf16_f32 v72, v72, v73
    v_cvt_pk_bf16_f32 v73, v74, v75
    s_mov_b64 exec, 0xf
    buffer_store_dwordx2 v[72:73], v229, s[88:91], 0 offen
    s_cmp_lg_u32 s2, 0
    s_cbranch_scc1 L_fin
    s_mov_b64 exec, 1
    buffer_store_dword v230, v231, s[96:99], 0 offen
L_fin:
L_end:
    s_endpgm
.section .rodata,"a"
.p2align 6
.amdhsa_kernel gated_mix__sliding_block_cached__glu_gated_reglu__decode_kernel
  .amdhsa_next_free_vgpr 256
  .amdhsa_next_free_sgpr 102
  .amdhsa_accum_offset 256
  .amdhsa_group_segment_fixed_size 0
  .amdhsa_kernarg_size 104
  .amdhsa_user_sgpr_count 2
  .amdhsa_user_sgpr_kernarg_segment_ptr 1
  .amdhsa_system_sgpr_workgroup_id_x 1
.end_amdhsa_kernel
```
